```python
import torch

def _softmax(x, axis=-1):
    return torch.softmax(x, dim=axis)
def _gelu(x):
    return torch.nn.functional.gelu(x, approximate="tanh")
def _silu(x):
    return torch.nn.functional.silu(x)
def _sigmoid(x):
    return torch.sigmoid(x)
def _layernorm(x, axis=-1, eps=1e-5):
    m = x.mean(dim=axis, keepdim=True)
    v = x.var(dim=axis, keepdim=True, unbiased=False)
    return (x - m) / torch.sqrt(v + eps)
def _scatter_add(tgt, idx, src, axis=0):
    return tgt.clone().index_add_(axis, idx, src)
def _segment_sum(src, seg, n):
    out = torch.zeros((n,) + src.shape[1:], dtype=src.dtype)
    return out.index_add_(0, seg, src)
def _pad(x, pw):
    flat = tuple(v for pair in reversed(pw) for v in pair)
    return torch.nn.functional.pad(x, flat)

kernel_name = 'recurrent_scan__ssm_conv_h3__glu_gated_swiglu__prompt'

def setup_inputs():

    _w = (lambda a: (lambda t: t.to(torch.bfloat16) if t.is_floating_point() else t)(torch.as_tensor(a)))
    def _A_setup():
        B, S, D = 1, 2048, 448
        ks = 4
        return {
            "q": _w((lambda *s: torch.randn(*s, dtype=torch.bfloat16) * 0.05)(B, S, D)),
            "k": _w((lambda *s: torch.randn(*s, dtype=torch.bfloat16) * 0.8)(B, S, D)),
            "v": _w((lambda *s: torch.randn(*s, dtype=torch.bfloat16) * 0.8)(B, S, D)),
            "shift_k": _w((lambda *s: torch.randn(*s, dtype=torch.bfloat16) * 0.8)(D, ks) * 0.5),
            "ssm_k": _w((lambda *s: torch.randn(*s, dtype=torch.bfloat16) * 0.8)(D, S) * (1.0 / S ** 0.5)),
            "ssm_D": _w((lambda *s: torch.randn(*s, dtype=torch.bfloat16) * 0.8)(D)),
        }
    _A_in = _A_setup()

    def _B_setup():
        B, S, D, F = 1, 2048, 448, 1792
        return {
            "x": _w((lambda *s: torch.randn(*s, dtype=torch.bfloat16) * 0.05)(B, S, D)),
            "w1": _w((lambda *s: torch.randn(*s, dtype=torch.bfloat16) * 0.2)(D, F) * (2.0 / D) ** 0.5),
            "w3": _w((lambda *s: torch.randn(*s, dtype=torch.bfloat16) * 0.2)(D, F) * (2.0 / D) ** 0.5),
            "w2": _w((lambda *s: torch.randn(*s, dtype=torch.bfloat16) * 0.2)(F, D) * (2.0 / F) ** 0.5),
        }
    _B_in = _B_setup()

    return {
        "A_q": _A_in["q"],
        "A_k": _A_in["k"],
        "A_v": _A_in["v"],
        "A_shift_k": _A_in["shift_k"],
        "A_ssm_k": _A_in["ssm_k"],
        "A_ssm_D": _A_in["ssm_D"],
        "B_x": _B_in["x"],
        "B_w1": _B_in["w1"],
        "B_w3": _B_in["w3"],
        "B_w2": _B_in["w2"],
    }

def reference(A_q, A_k, A_v, A_shift_k, A_ssm_k, A_ssm_D, B_x, B_w1, B_w3, B_w2):
    def _A_ref(q, k, v, shift_k, ssm_k, ssm_D):
        B, S, D = q.shape
        ks = shift_k.shape[-1]
        k_pad = _pad(k, ((0, 0), (ks - 1, 0), (0, 0)))
        k_shift = torch.zeros_like(k)
        for t in range(ks):
            k_shift = k_shift + k_pad[:, t:t + S, :] * shift_k[:, ks - 1 - t][None, None, :]
        kv = k_shift * v
        L = 2 * S
        kv_pad = _pad(kv, ((0, 0), (0, S), (0, 0)))
        kf_pad = _pad(ssm_k, ((0, 0), (0, S)))
        kv_f = (lambda x, axes=(-2,-1): torch.fft.rfft2(x.float(), dim=axes))(kv_pad[:, None, :, :], axes=(1, 2))
        kf_f = (lambda x, axes=(-2,-1): torch.fft.rfft2(x.float(), dim=axes))(kf_pad[:, None, :], axes=(1, 2))
        kf_f = (lambda x, *d: x.permute(*d))(kf_f, 1, 2, 0)
        y_f = kv_f * kf_f[None, :, :, :]
        y = (lambda x, s, axes=(-2,-1): torch.fft.irfft2(x, s=s, dim=axes).to(torch.bfloat16))(y_f, (1, L), axes=(1, 2))[:, 0, :S, :]
        y = y + kv * ssm_D[None, None, :]
        return q * y

    def _B_ref(x, w1, w3, w2):
        gate = torch.einsum("bsd,df->bsf", x, w1)
        up = torch.einsum("bsd,df->bsf", x, w3)
        h = _silu(gate) * up
        out = torch.einsum("bsf,fd->bsd", h, w2)
        return out

    x = A_q
    xn = _layernorm(x, axis=-1)
    s = _A_ref(xn, A_k, A_v, A_shift_k, A_ssm_k, A_ssm_D)
    g = _silu(_B_ref(xn, B_w1, B_w3, B_w2))
    return x + s * g
```

```asm
; @launch grid=(256,1,1) block=(512,1,1) lds=162048
.amdgcn_target "amdgcn-amd-amdhsa--gfx950"
.text
.globl recurrent_scan__ssm_conv_h3__glu_gated_swiglu__prompt_kernel
.p2align 8
.type recurrent_scan__ssm_conv_h3__glu_gated_swiglu__prompt_kernel,@function
recurrent_scan__ssm_conv_h3__glu_gated_swiglu__prompt_kernel:
    s_cmp_ge_u32 s2, 256
    s_cbranch_scc1 Lend
    s_load_dwordx16 s[16:31], s[0:1], 0
    s_load_dwordx8 s[32:39], s[0:1], 64
    s_load_dwordx2 s[40:41], s[0:1], 96
Lpc0:
    s_getpc_b64 s[8:9]
    v_lshlrev_b32 v3, 7, v0
    v_min_u32 v3, Lcode_end-Lpc0-8, v3
    global_load_dword v140, v3, s[8:9]
    v_and_b32 v1, 63, v0
    v_lshrrev_b32 v2, 6, v0
    s_nop 0
    v_readfirstlane_b32 s3, v2
    v_lshlrev_b32 v12, 4, v1
    v_lshlrev_b32 v13, 2, v1
    s_mov_b32 s14, 0xffff0000
    s_waitcnt lgkmcnt(0)
    s_memrealtime s[0:1]
    s_mov_b32 s44, s16
    s_mov_b32 s45, s17
    s_mov_b32 s46, 1835008
    s_mov_b32 s47, 0x20000
    s_cmp_ge_u32 s3, 4
    s_cselect_b32 s48, s32, s30
    s_cselect_b32 s49, s33, s31
    s_mov_b32 s50, 1605632
    s_mov_b32 s51, 0x20000
    s_mov_b32 s52, s40
    s_mov_b32 s53, s41
    s_mov_b32 s54, 25165824
    s_mov_b32 s55, 0x20000
    s_mov_b32 s56, s18
    s_mov_b32 s57, s19
    s_mov_b32 s58, 1835008
    s_mov_b32 s59, 0x20000
    s_mov_b32 s60, s20
    s_mov_b32 s61, s21
    s_mov_b32 s62, 1835008
    s_mov_b32 s63, 0x20000
    s_mov_b32 s64, s22
    s_mov_b32 s65, s23
    s_mov_b32 s66, 3584
    s_mov_b32 s67, 0x20000
    s_mov_b32 s72, s26
    s_mov_b32 s73, s27
    s_mov_b32 s74, 896
    s_mov_b32 s75, 0x20000
    s_mov_b32 s76, s34
    s_mov_b32 s77, s35
    s_mov_b32 s78, 1605632
    s_mov_b32 s79, 0x20000
    s_mov_b32 s80, s36
    s_mov_b32 s81, s37
    s_mov_b32 s82, 1835008
    s_mov_b32 s83, 0x20000
    s_mov_b32 s84, s38
    s_mov_b32 s85, s39
    s_mov_b32 s86, 256
    s_mov_b32 s87, 0x20000
    s_waitcnt lgkmcnt(0)
    s_cmp_ge_u32 s2, 224
    s_cbranch_scc1 Laux
    s_and_b32 s4, s3, 1
    s_lshr_b32 s5, s3, 1
    s_and_b32 s8, s2, 7
    s_lshr_b32 s9, s2, 3
    s_and_b32 s10, s9, 3
    s_lshr_b32 s11, s9, 2
    s_lshr_b32 s6, s8, 1
    s_lshl_b32 s6, s6, 2
    s_add_u32 s6, s6, s10
    s_and_b32 s7, s8, 1
    s_mul_i32 s7, s7, 7
    s_add_u32 s7, s7, s11
    v_lshrrev_b32 v20, 3, v1
    v_and_b32 v21, 7, v1
    v_lshrrev_b32 v22, 4, v1
    s_lshl_b32 s8, s3, 4
    v_add_u32 v23, s8, v20
    v_mul_u32_u24 v23, 896, v23
    v_xor_b32 v24, v21, v22
    v_lshl_add_u32 v2, v24, 4, v23
    v_xor_b32 v24, 4, v24
    v_lshl_add_u32 v3, v24, 4, v23
    v_add_u32 v3, 7168, v3
    s_and_b32 s8, s3, 3
    s_lshl_b32 s8, s8, 4
    v_add_u32 v23, s8, v20
    v_mul_u32_u24 v23, 3584, v23
    s_lshr_b32 s9, s3, 2
    s_lshl_b32 s9, s9, 1
    v_bfe_u32 v24, v1, 4, 1
    v_or_b32 v24, s9, v24
    v_bfe_u32 v25, v1, 1, 2
    v_xor_b32 v24, v24, v25
    v_and_b32 v26, 1, v1
    v_lshl_or_b32 v27, v24, 1, v26
    v_lshl_add_u32 v4, v27, 4, v23
    s_mul_i32 s88, s6, 114688
    s_lshl_b32 s89, s7, 8
    s_lshl_b32 s90, s3, 11
    s_lshl_b32 s91, s3, 12
    s_add_u32 m0, s90, 0
    s_add_u32 s8, s88, 0
    buffer_load_dwordx4 v2, s[44:47], s8 offen lds
    s_add_u32 m0, s90, 1024
    s_add_u32 s8, s88, 0
    buffer_load_dwordx4 v3, s[44:47], s8 offen lds
    s_add_u32 m0, s90, 16384
    s_add_u32 s8, s89, 0
    buffer_load_dwordx4 v4, s[48:51], s8 offen lds
    s_add_u32 m0, s90, 17408
    s_add_u32 s8, s89, 28672
    buffer_load_dwordx4 v4, s[48:51], s8 offen lds
    s_add_u32 m0, s90, 32768
    s_add_u32 s8, s88, 128
    buffer_load_dwordx4 v2, s[44:47], s8 offen lds
    s_add_u32 m0, s90, 33792
    s_add_u32 s8, s88, 128
    buffer_load_dwordx4 v3, s[44:47], s8 offen lds
    s_add_u32 m0, s90, 49152
    s_add_u32 s8, s89, 229376
    buffer_load_dwordx4 v4, s[48:51], s8 offen lds
    s_add_u32 m0, s90, 50176
    s_add_u32 s8, s89, 258048
    buffer_load_dwordx4 v4, s[48:51], s8 offen lds
    s_add_u32 m0, s90, 65536
    s_add_u32 s8, s88, 256
    buffer_load_dwordx4 v2, s[44:47], s8 offen lds
    s_add_u32 m0, s90, 66560
    s_add_u32 s8, s88, 256
    buffer_load_dwordx4 v3, s[44:47], s8 offen lds
    s_add_u32 m0, s90, 81920
    s_add_u32 s8, s89, 458752
    buffer_load_dwordx4 v4, s[48:51], s8 offen lds
    s_add_u32 m0, s90, 82944
    s_add_u32 s8, s89, 487424
    buffer_load_dwordx4 v4, s[48:51], s8 offen lds
    s_add_u32 m0, s90, 98304
    s_add_u32 s8, s88, 384
    buffer_load_dwordx4 v2, s[44:47], s8 offen lds
    s_add_u32 m0, s90, 99328
    s_add_u32 s8, s88, 384
    buffer_load_dwordx4 v3, s[44:47], s8 offen lds
    s_add_u32 m0, s90, 114688
    s_add_u32 s8, s89, 688128
    buffer_load_dwordx4 v4, s[48:51], s8 offen lds
    s_add_u32 m0, s90, 115712
    s_add_u32 s8, s89, 716800
    buffer_load_dwordx4 v4, s[48:51], s8 offen lds
    s_add_u32 m0, s90, 131072
    s_add_u32 s8, s88, 512
    buffer_load_dwordx4 v2, s[44:47], s8 offen lds
    s_add_u32 m0, s90, 132096
    s_add_u32 s8, s88, 512
    buffer_load_dwordx4 v3, s[44:47], s8 offen lds
    s_cmp_lg_u32 s3, 7
    s_cbranch_scc1 Ltlb_1
    buffer_load_dword v140, off, s[72:75], 0
    buffer_load_dword v140, off, s[80:83], 0
    v_lshlrev_b32 v25, 21, v1
    v_add_u32 v25, 2097024, v25
    v_subrev_u32 v26, 4, v1
    v_mul_u32_u24 v26, 918528, v26
    v_add_u32 v26, 8503296, v26
    v_cmp_gt_u32 vcc, 4, v1
    s_nop 1
    v_cndmask_b32 v25, v26, v25, vcc
    v_cmp_gt_u32 vcc, 12, v1
    v_mov_b32 v26, 0x80000000
    s_nop 0
    v_cndmask_b32 v25, v26, v25, vcc
    buffer_load_dword v140, v25, s[52:55], 0 offen
Ltlb_1:
    s_mul_hi_u32 s12, s2, 0x24924925
    s_mul_i32 s13, s12, 7
    s_sub_u32 s13, s2, s13
    v_and_b32 v23, 31, v1
    v_lshrrev_b32 v24, 5, v1
    v_mul_u32_u24 v25, 3584, v24
    v_lshl_add_u32 v25, v23, 2, v25
    s_mul_i32 s8, s12, 57344
    s_lshl_b32 s9, s13, 7
    s_add_u32 s8, s8, s9
    s_mul_i32 s9, s3, 7168
    s_add_u32 s8, s8, s9
    v_add_u32 v112, s8, v25
    v_lshlrev_b32 v113, 4, v23
    s_lshl_b32 s8, s3, 4
    s_sub_u32 s8, 147576, s8
    v_mul_u32_u24 v114, 272, v23
    v_lshlrev_b32 v25, 3, v24
    v_sub_u32 v114, v114, v25
    v_add_u32 v114, s8, v114
    s_mul_i32 s8, s3, 1088
    s_add_u32 s8, s8, 147456
    v_mul_u32_u24 v115, 136, v20
    v_lshl_add_u32 v115, v21, 4, v115
    v_add_u32 v115, s8, v115
    v_lshlrev_b32 v116, 12, v20
    v_lshl_add_u32 v116, v21, 4, v116
    s_lshl_b32 s15, s13, 18
    s_lshl_b32 s9, s3, 15
    s_add_u32 s15, s15, s9
    s_sub_u32 s9, 31, s12
    s_lshl_b32 s9, s9, 7
    s_add_u32 s15, s15, s9
    s_lshl_b32 s43, s13, 5
    s_add_u32 s43, s43, s12
    s_lshl_b32 s8, s13, 9
    buffer_load_dwordx4 v[60:63], v113, s[64:67], s8 offen
    v_subrev_u32 v117, 2688, v112
    buffer_load_dword v48, v117, s[56:59], 0 offen
    v_subrev_u32 v117, 1792, v112
    buffer_load_dword v49, v117, s[56:59], 0 offen
    v_subrev_u32 v117, 896, v112
    buffer_load_dword v50, v117, s[56:59], 0 offen
    buffer_load_dword v51, v112, s[56:59], 0 offen offset:0
    buffer_load_dword v55, v112, s[60:63], 0 offen offset:0
    buffer_load_dword v52, v112, s[56:59], 0 offen offset:896
    buffer_load_dword v56, v112, s[60:63], 0 offen offset:896
    buffer_load_dword v53, v112, s[56:59], 0 offen offset:1792
    buffer_load_dword v57, v112, s[60:63], 0 offen offset:1792
    buffer_load_dword v54, v112, s[56:59], 0 offen offset:2688
    buffer_load_dword v58, v112, s[60:63], 0 offen offset:2688
    v_bfe_u32 v25, v1, 1, 3
    s_and_b32 s8, s3, 3
    s_lshl_b32 s8, s8, 12
    v_lshlrev_b32 v26, 7, v23
    v_add_u32 v26, s8, v26
    v_xor_b32 v27, v24, v25
    v_lshl_add_u32 v5, v27, 4, v26
    v_bfe_u32 v23, v1, 4, 1
    v_bfe_u32 v25, v1, 2, 2
    v_bfe_u32 v26, v1, 3, 1
    v_lshl_or_b32 v26, v23, 1, v26
    v_lshl_add_u32 v27, v24, 3, v25
    v_lshlrev_b32 v27, 7, v27
    v_lshl_add_u32 v27, v23, 13, v27
    v_and_b32 v28, 3, v1
    v_lshl_add_u32 v27, v28, 3, v27
    s_lshr_b32 s8, s3, 2
    s_lshl_b32 s8, s8, 1
    s_add_u32 s8, s8, 0
    v_xor_b32 v28, s8, v26
    v_lshl_add_u32 v142, v28, 5, v27
    s_lshr_b32 s8, s3, 2
    s_lshl_b32 s8, s8, 1
    s_add_u32 s8, s8, 1
    v_xor_b32 v28, s8, v26
    v_lshl_add_u32 v143, v28, 5, v27
    s_and_b32 s8, s2, 7
    s_lshr_b32 s9, s2, 3
    s_mul_hi_u32 s10, s9, 0x24924925
    s_mul_i32 s11, s10, 7
    s_sub_u32 s93, s9, s11
    s_lshl_b32 s92, s8, 2
    s_add_u32 s92, s92, s10
    s_mul_i32 s95, s5, 14
    s_add_u32 s95, s95, s4
    s_lshl_b32 s69, s93, 7
    v_mul_u32_u24 v9, 896, v20
    v_lshl_add_u32 v9, v21, 4, v9
    v_bfe_u32 v23, v1, 4, 1
    v_lshlrev_b32 v23, 6, v23
    v_xor_b32 v9, v23, v9
    v_lshrrev_b32 v23, 7, v0
    v_mul_u32_u24 v23, 4096, v23
    v_lshl_add_u32 v0, v0, 4, v23
    v_add_u32 v0, 118784, v0
    s_lshr_b32 s8, s3, 2
    s_mul_i32 s8, s8, 14336
    s_lshl_b32 s9, s7, 10
    s_add_u32 s8, s8, s9
    s_and_b32 s9, s3, 3
    s_lshl_b32 s9, s9, 8
    s_add_u32 s8, s8, s9
    s_add_u32 s68, s8, 6356992
    s_lshl_b32 s8, s6, 2
    s_and_b32 s9, s3, 3
    s_add_u32 s8, s8, s9
    s_mul_i32 s70, s8, 114816
    s_lshl_b32 s10, s7, 12
    s_add_u32 s70, s70, s10
    s_lshr_b32 s10, s3, 2
    s_lshl_b32 s11, s10, 11
    s_add_u32 s70, s70, s11
    s_add_u32 s70, s70, 8388608
    s_lshr_b32 s71, s8, 1
    s_lshl_b32 s71, s71, 8
    s_and_b32 s8, s8, 1
    s_mul_i32 s8, s8, 112
    s_add_u32 s71, s71, s8
    s_lshl_b32 s8, s7, 3
    s_add_u32 s71, s71, s8
    s_lshl_b32 s8, s10, 2
    s_add_u32 s71, s71, s8
    s_add_u32 s71, s71, 6455296
    s_waitcnt vmcnt(26) lgkmcnt(0)
    s_barrier
    v_add_u32 v10, 16384, v142
    v_add_u32 v11, 16384, v143
    v_add_u32 v6, 0, v5
    ds_read_b64_tr_b16 v[80:81], v10 offset:0
    ds_read_b64_tr_b16 v[82:83], v10 offset:512
    ds_read_b64_tr_b16 v[84:85], v11 offset:0
    ds_read_b64_tr_b16 v[86:87], v11 offset:512
    v_xor_b32 v7, 0, v6
    ds_read_b128 v[144:147], v7
    ds_read_b64_tr_b16 v[88:89], v10 offset:2048
    ds_read_b64_tr_b16 v[90:91], v10 offset:2560
    ds_read_b64_tr_b16 v[92:93], v11 offset:2048
    ds_read_b64_tr_b16 v[94:95], v11 offset:2560
    v_xor_b32 v8, 32, v6
    ds_read_b128 v[148:151], v8
    s_waitcnt lgkmcnt(5)
    v_mfma_f32_32x32x16_bf16 v[16:31], v[80:83], v[144:147], 0
    ds_read_b64_tr_b16 v[96:97], v10 offset:4096
    ds_read_b64_tr_b16 v[98:99], v10 offset:4608
    ds_read_b64_tr_b16 v[100:101], v11 offset:4096
    ds_read_b64_tr_b16 v[102:103], v11 offset:4608
    v_xor_b32 v7, 64, v6
    ds_read_b128 v[152:155], v7
    v_mfma_f32_32x32x16_bf16 v[32:47], v[84:87], v[144:147], 0
    ds_read_b64_tr_b16 v[104:105], v10 offset:6144
    ds_read_b64_tr_b16 v[106:107], v10 offset:6656
    ds_read_b64_tr_b16 v[108:109], v11 offset:6144
    ds_read_b64_tr_b16 v[110:111], v11 offset:6656
    v_xor_b32 v8, 96, v6
    ds_read_b128 v[156:159], v8
    s_waitcnt lgkmcnt(10)
    v_mfma_f32_32x32x16_bf16 v[16:31], v[88:91], v[148:151], v[16:31]
    v_mfma_f32_32x32x16_bf16 v[32:47], v[92:95], v[148:151], v[32:47]
    s_waitcnt vmcnt(22) lgkmcnt(0)
    s_barrier
    v_mfma_f32_32x32x16_bf16 v[16:31], v[96:99], v[152:155], v[16:31]
    v_add_u32 v10, 49152, v142
    v_add_u32 v11, 49152, v143
    v_add_u32 v6, 32768, v5
    ds_read_b64_tr_b16 v[80:81], v10 offset:0
    ds_read_b64_tr_b16 v[82:83], v10 offset:512
    ds_read_b64_tr_b16 v[84:85], v11 offset:0
    ds_read_b64_tr_b16 v[86:87], v11 offset:512
    v_xor_b32 v7, 0, v6
    ds_read_b128 v[160:163], v7
    s_add_u32 m0, s90, 0
    s_add_u32 s8, s89, 917504
    buffer_load_dwordx4 v4, s[48:51], s8 offen lds
    v_mfma_f32_32x32x16_bf16 v[32:47], v[100:103], v[152:155], v[32:47]
    ds_read_b64_tr_b16 v[88:89], v10 offset:2048
    ds_read_b64_tr_b16 v[90:91], v10 offset:2560
    ds_read_b64_tr_b16 v[92:93], v11 offset:2048
    ds_read_b64_tr_b16 v[94:95], v11 offset:2560
    v_xor_b32 v8, 32, v6
    ds_read_b128 v[164:167], v8
    ds_read_b64_tr_b16 v[96:97], v10 offset:4096
    ds_read_b64_tr_b16 v[98:99], v10 offset:4608
    ds_read_b64_tr_b16 v[100:101], v11 offset:4096
    ds_read_b64_tr_b16 v[102:103], v11 offset:4608
    v_xor_b32 v7, 64, v6
    ds_read_b128 v[168:171], v7
    s_add_u32 m0, s90, 1024
    s_add_u32 s8, s89, 946176
    buffer_load_dwordx4 v4, s[48:51], s8 offen lds
    v_mfma_f32_32x32x16_bf16 v[16:31], v[104:107], v[156:159], v[16:31]
    s_add_u32 m0, s90, 16384
    s_add_u32 s8, s88, 640
    buffer_load_dwordx4 v2, s[44:47], s8 offen lds
    v_mfma_f32_32x32x16_bf16 v[32:47], v[108:111], v[156:159], v[32:47]
    ds_read_b64_tr_b16 v[104:105], v10 offset:6144
    ds_read_b64_tr_b16 v[106:107], v10 offset:6656
    ds_read_b64_tr_b16 v[108:109], v11 offset:6144
    ds_read_b64_tr_b16 v[110:111], v11 offset:6656
    v_xor_b32 v8, 96, v6
    ds_read_b128 v[172:175], v8
    s_add_u32 m0, s90, 17408
    s_add_u32 s8, s88, 640
    buffer_load_dwordx4 v3, s[44:47], s8 offen lds
    s_waitcnt lgkmcnt(15)
    v_mfma_f32_32x32x16_bf16 v[16:31], v[80:83], v[160:163], v[16:31]
    s_cmp_lg_u32 s3, 0
    s_cbranch_scc1 Lw0_2
    buffer_load_dword v139, off, s[84:87], 0 sc1
Lw0_2:
    v_mfma_f32_32x32x16_bf16 v[32:47], v[84:87], v[160:163], v[32:47]
    s_cmp_lg_u32 s3, 6
    s_cbranch_scc1 Ltsk_3
    s_lshl_b32 s8, s2, 13
    v_lshlrev_b32 v141, 7, v1
    v_add_u32 v141, s8, v141
    global_load_dword v140, v141, s[24:25]
Ltsk_3:
    s_waitcnt lgkmcnt(10)
    v_mfma_f32_32x32x16_bf16 v[16:31], v[88:91], v[164:167], v[16:31]
    s_cmp_lg_u32 s3, 7
    s_cbranch_scc1 Ltw2_4
    s_mul_i32 s8, s2, 7168
    v_lshlrev_b32 v141, 7, v1
    v_min_u32 v141, 7040, v141
    buffer_load_dword v140, v141, s[76:79], s8 offen
Ltw2_4:
    v_mfma_f32_32x32x16_bf16 v[32:47], v[92:95], v[164:167], v[32:47]
    s_waitcnt vmcnt(22) lgkmcnt(0)
    s_barrier
    v_mfma_f32_32x32x16_bf16 v[16:31], v[96:99], v[168:171], v[16:31]
    v_add_u32 v10, 81920, v142
    v_add_u32 v11, 81920, v143
    v_add_u32 v6, 65536, v5
    ds_read_b64_tr_b16 v[80:81], v10 offset:0
    ds_read_b64_tr_b16 v[82:83], v10 offset:512
    ds_read_b64_tr_b16 v[84:85], v11 offset:0
    ds_read_b64_tr_b16 v[86:87], v11 offset:512
    v_xor_b32 v7, 0, v6
    ds_read_b128 v[176:179], v7
    s_add_u32 m0, s90, 32768
    s_add_u32 s8, s89, 1146880
    buffer_load_dwordx4 v4, s[48:51], s8 offen lds
    v_mfma_f32_32x32x16_bf16 v[32:47], v[100:103], v[168:171], v[32:47]
    ds_read_b64_tr_b16 v[88:89], v10 offset:2048
    ds_read_b64_tr_b16 v[90:91], v10 offset:2560
    ds_read_b64_tr_b16 v[92:93], v11 offset:2048
    ds_read_b64_tr_b16 v[94:95], v11 offset:2560
    v_xor_b32 v8, 32, v6
    ds_read_b128 v[180:183], v8
    ds_read_b64_tr_b16 v[96:97], v10 offset:4096
    ds_read_b64_tr_b16 v[98:99], v10 offset:4608
    ds_read_b64_tr_b16 v[100:101], v11 offset:4096
    ds_read_b64_tr_b16 v[102:103], v11 offset:4608
    v_xor_b32 v7, 64, v6
    ds_read_b128 v[184:187], v7
    s_add_u32 m0, s90, 33792
    s_add_u32 s8, s89, 1175552
    buffer_load_dwordx4 v4, s[48:51], s8 offen lds
    v_mfma_f32_32x32x16_bf16 v[16:31], v[104:107], v[172:175], v[16:31]
    v_mfma_f32_32x32x16_bf16 v[32:47], v[108:111], v[172:175], v[32:47]
    ds_read_b64_tr_b16 v[104:105], v10 offset:6144
    ds_read_b64_tr_b16 v[106:107], v10 offset:6656
    ds_read_b64_tr_b16 v[108:109], v11 offset:6144
    ds_read_b64_tr_b16 v[110:111], v11 offset:6656
    v_xor_b32 v8, 96, v6
    ds_read_b128 v[188:191], v8
    s_add_u32 m0, s90, 49152
    s_add_u32 s8, s88, 768
    buffer_load_dwordx4 v2, s[44:47], s8 offen lds
    s_waitcnt lgkmcnt(15)
    v_mfma_f32_32x32x16_bf16 v[16:31], v[80:83], v[176:179], v[16:31]
    v_mfma_f32_32x32x16_bf16 v[32:47], v[84:87], v[176:179], v[32:47]
    s_add_u32 m0, s90, 50176
    s_add_u32 s8, s88, 768
    buffer_load_dwordx4 v3, s[44:47], s8 offen lds
    s_waitcnt lgkmcnt(10)
    v_mfma_f32_32x32x16_bf16 v[16:31], v[88:91], v[180:183], v[16:31]
    v_mfma_f32_32x32x16_bf16 v[32:47], v[92:95], v[180:183], v[32:47]
    s_waitcnt vmcnt(8) lgkmcnt(0)
    s_barrier
    v_mfma_f32_32x32x16_bf16 v[16:31], v[96:99], v[184:187], v[16:31]
    v_add_u32 v10, 114688, v142
    v_add_u32 v11, 114688, v143
    v_add_u32 v6, 98304, v5
    ds_read_b64_tr_b16 v[80:81], v10 offset:0
    ds_read_b64_tr_b16 v[82:83], v10 offset:512
    ds_read_b64_tr_b16 v[84:85], v11 offset:0
    ds_read_b64_tr_b16 v[86:87], v11 offset:512
    v_xor_b32 v7, 0, v6
    ds_read_b128 v[192:195], v7
    s_add_u32 m0, s90, 65536
    s_add_u32 s8, s89, 1376256
    buffer_load_dwordx4 v4, s[48:51], s8 offen lds
    v_lshlrev_b32 v64, 16, v60
    v_and_b32 v65, s14, v60
    v_lshlrev_b32 v66, 16, v61
    v_and_b32 v67, s14, v61
    v_lshlrev_b32 v68, 16, v48
    v_mfma_f32_32x32x16_bf16 v[32:47], v[100:103], v[184:187], v[32:47]
    ds_read_b64_tr_b16 v[88:89], v10 offset:2048
    ds_read_b64_tr_b16 v[90:91], v10 offset:2560
    ds_read_b64_tr_b16 v[92:93], v11 offset:2048
    ds_read_b64_tr_b16 v[94:95], v11 offset:2560
    v_xor_b32 v8, 32, v6
    ds_read_b128 v[196:199], v8
    ds_read_b64_tr_b16 v[96:97], v10 offset:4096
    ds_read_b64_tr_b16 v[98:99], v10 offset:4608
    ds_read_b64_tr_b16 v[100:101], v11 offset:4096
    ds_read_b64_tr_b16 v[102:103], v11 offset:4608
    v_xor_b32 v7, 64, v6
    ds_read_b128 v[200:203], v7
    s_add_u32 m0, s90, 66560
    s_add_u32 s8, s89, 1404928
    buffer_load_dwordx4 v4, s[48:51], s8 offen lds
    v_lshlrev_b32 v69, 16, v49
    v_lshlrev_b32 v70, 16, v50
    v_lshlrev_b32 v71, 16, v51
    v_lshlrev_b32 v72, 16, v52
    v_lshlrev_b32 v73, 16, v53
    v_mfma_f32_32x32x16_bf16 v[16:31], v[104:107], v[188:191], v[16:31]
    v_lshlrev_b32 v74, 16, v54
    v_mul_f32 v76, v64, v71
    v_mul_f32 v77, v64, v72
    v_mul_f32 v78, v64, v73
    v_mul_f32 v79, v64, v74
    v_mfma_f32_32x32x16_bf16 v[32:47], v[108:111], v[188:191], v[32:47]
    ds_read_b64_tr_b16 v[104:105], v10 offset:6144
    ds_read_b64_tr_b16 v[106:107], v10 offset:6656
    ds_read_b64_tr_b16 v[108:109], v11 offset:6144
    ds_read_b64_tr_b16 v[110:111], v11 offset:6656
    v_xor_b32 v8, 96, v6
    ds_read_b128 v[204:207], v8
    s_add_u32 m0, s90, 81920
    s_add_u32 s8, s89, 128
    buffer_load_dwordx4 v4, s[48:51], s8 offen lds
    v_fmac_f32 v76, v65, v70
    v_fmac_f32 v77, v65, v71
    v_fmac_f32 v78, v65, v72
    v_fmac_f32 v79, v65, v73
    s_waitcnt lgkmcnt(15)
    v_mfma_f32_32x32x16_bf16 v[16:31], v[80:83], v[192:195], v[16:31]
    v_fmac_f32 v76, v66, v69
    v_fmac_f32 v77, v66, v70
    v_fmac_f32 v78, v66, v71
    v_fmac_f32 v79, v66, v72
    v_fmac_f32 v76, v67, v68
    v_mfma_f32_32x32x16_bf16 v[32:47], v[84:87], v[192:195], v[32:47]
    s_add_u32 m0, s90, 82944
    s_add_u32 s8, s89, 28800
    buffer_load_dwordx4 v4, s[48:51], s8 offen lds
    v_fmac_f32 v77, v67, v69
    v_fmac_f32 v78, v67, v70
    v_fmac_f32 v79, v67, v71
    v_lshlrev_b32 v68, 16, v55
    v_lshlrev_b32 v69, 16, v56
    s_waitcnt lgkmcnt(10)
    v_mfma_f32_32x32x16_bf16 v[16:31], v[88:91], v[196:199], v[16:31]
    v_lshlrev_b32 v70, 16, v57
    v_lshlrev_b32 v71, 16, v58
    v_mul_f32 v76, v76, v68
    v_mul_f32 v77, v77, v69
    v_mul_f32 v78, v78, v70
    v_mfma_f32_32x32x16_bf16 v[32:47], v[92:95], v[196:199], v[32:47]
    v_mul_f32 v79, v79, v71
    v_cvt_pk_bf16_f32 v118, v79, v78
    v_cvt_pk_bf16_f32 v119, v77, v76
    ds_write_b64 v114, v[118:119] offset:0
    s_waitcnt vmcnt(10) lgkmcnt(0)
    s_barrier
    v_mfma_f32_32x32x16_bf16 v[16:31], v[96:99], v[200:203], v[16:31]
    v_add_u32 v10, 0, v142
    v_add_u32 v11, 0, v143
    v_add_u32 v6, 131072, v5
    ds_read_b64_tr_b16 v[80:81], v10 offset:0
    ds_read_b64_tr_b16 v[82:83], v10 offset:512
    ds_read_b64_tr_b16 v[84:85], v11 offset:0
    ds_read_b64_tr_b16 v[86:87], v11 offset:512
    v_xor_b32 v7, 0, v6
    ds_read_b128 v[208:211], v7
    s_add_u32 m0, s90, 98304
    s_add_u32 s8, s89, 229504
    buffer_load_dwordx4 v4, s[48:51], s8 offen lds
    v_lshlrev_b32 v64, 16, v62
    v_and_b32 v65, s14, v62
    v_lshlrev_b32 v66, 16, v63
    v_and_b32 v67, s14, v63
    v_and_b32 v68, s14, v48
    v_mfma_f32_32x32x16_bf16 v[32:47], v[100:103], v[200:203], v[32:47]
    ds_read_b64_tr_b16 v[88:89], v10 offset:2048
    ds_read_b64_tr_b16 v[90:91], v10 offset:2560
    ds_read_b64_tr_b16 v[92:93], v11 offset:2048
    ds_read_b64_tr_b16 v[94:95], v11 offset:2560
    v_xor_b32 v8, 32, v6
    ds_read_b128 v[212:215], v8
    ds_read_b64_tr_b16 v[96:97], v10 offset:4096
    ds_read_b64_tr_b16 v[98:99], v10 offset:4608
    ds_read_b64_tr_b16 v[100:101], v11 offset:4096
    ds_read_b64_tr_b16 v[102:103], v11 offset:4608
    v_xor_b32 v7, 64, v6
    ds_read_b128 v[216:219], v7
    s_add_u32 m0, s90, 99328
    s_add_u32 s8, s89, 258176
    buffer_load_dwordx4 v4, s[48:51], s8 offen lds
    v_and_b32 v69, s14, v49
    v_and_b32 v70, s14, v50
    v_and_b32 v71, s14, v51
    v_and_b32 v72, s14, v52
    v_and_b32 v73, s14, v53
    v_mfma_f32_32x32x16_bf16 v[16:31], v[104:107], v[204:207], v[16:31]
    v_and_b32 v74, s14, v54
    v_mul_f32 v76, v64, v71
    v_mul_f32 v77, v64, v72
    v_mul_f32 v78, v64, v73
    v_mul_f32 v79, v64, v74
    v_mfma_f32_32x32x16_bf16 v[32:47], v[108:111], v[204:207], v[32:47]
    ds_read_b64_tr_b16 v[104:105], v10 offset:6144
    ds_read_b64_tr_b16 v[106:107], v10 offset:6656
    ds_read_b64_tr_b16 v[108:109], v11 offset:6144
    ds_read_b64_tr_b16 v[110:111], v11 offset:6656
    v_xor_b32 v8, 96, v6
    ds_read_b128 v[220:223], v8
    s_add_u32 m0, s90, 114688
    s_add_u32 s8, s89, 458880
    buffer_load_dwordx4 v4, s[48:51], s8 offen lds
    v_fmac_f32 v76, v65, v70
    v_fmac_f32 v77, v65, v71
    v_fmac_f32 v78, v65, v72
    v_fmac_f32 v79, v65, v73
    s_waitcnt lgkmcnt(15)
    v_mfma_f32_32x32x16_bf16 v[16:31], v[80:83], v[208:211], v[16:31]
    v_fmac_f32 v76, v66, v69
    v_fmac_f32 v77, v66, v70
    v_fmac_f32 v78, v66, v71
    v_fmac_f32 v79, v66, v72
    v_fmac_f32 v76, v67, v68
    v_mfma_f32_32x32x16_bf16 v[32:47], v[84:87], v[208:211], v[32:47]
    s_add_u32 m0, s90, 115712
    s_add_u32 s8, s89, 487552
    buffer_load_dwordx4 v4, s[48:51], s8 offen lds
    v_fmac_f32 v77, v67, v69
    v_fmac_f32 v78, v67, v70
    v_fmac_f32 v79, v67, v71
    v_and_b32 v68, s14, v55
    v_and_b32 v69, s14, v56
    s_waitcnt lgkmcnt(10)
    v_mfma_f32_32x32x16_bf16 v[16:31], v[88:91], v[212:215], v[16:31]
    v_and_b32 v70, s14, v57
    v_and_b32 v71, s14, v58
    v_mul_f32 v76, v76, v68
    v_mul_f32 v77, v77, v69
    v_mul_f32 v78, v78, v70
    v_mfma_f32_32x32x16_bf16 v[32:47], v[92:95], v[212:215], v[32:47]
    v_mul_f32 v79, v79, v71
    v_cvt_pk_bf16_f32 v120, v79, v78
    v_cvt_pk_bf16_f32 v121, v77, v76
    ds_write_b64 v114, v[120:121] offset:136
    s_waitcnt vmcnt(10) lgkmcnt(0)
    s_barrier
    v_mfma_f32_32x32x16_bf16 v[16:31], v[96:99], v[216:219], v[16:31]
    ds_read_b64 v[48:49], v115
    ds_read_b64 v[50:51], v115 offset:8
    v_add_u32 v10, 32768, v142
    v_add_u32 v11, 32768, v143
    v_add_u32 v6, 16384, v5
    ds_read_b64_tr_b16 v[80:81], v10 offset:0
    ds_read_b64_tr_b16 v[82:83], v10 offset:512
    ds_read_b64_tr_b16 v[84:85], v11 offset:0
    ds_read_b64_tr_b16 v[86:87], v11 offset:512
    v_xor_b32 v7, 0, v6
    ds_read_b128 v[224:227], v7
    s_add_u32 m0, s90, 131072
    s_add_u32 s8, s89, 688256
    buffer_load_dwordx4 v4, s[48:51], s8 offen lds
    v_mfma_f32_32x32x16_bf16 v[32:47], v[100:103], v[216:219], v[32:47]
    ds_read_b64_tr_b16 v[88:89], v10 offset:2048
    ds_read_b64_tr_b16 v[90:91], v10 offset:2560
    ds_read_b64_tr_b16 v[92:93], v11 offset:2048
    ds_read_b64_tr_b16 v[94:95], v11 offset:2560
    v_xor_b32 v8, 32, v6
    ds_read_b128 v[228:231], v8
    ds_read_b64_tr_b16 v[96:97], v10 offset:4096
    ds_read_b64_tr_b16 v[98:99], v10 offset:4608
    ds_read_b64_tr_b16 v[100:101], v11 offset:4096
    ds_read_b64_tr_b16 v[102:103], v11 offset:4608
    v_xor_b32 v7, 64, v6
    ds_read_b128 v[232:235], v7
    s_add_u32 m0, s90, 132096
    s_add_u32 s8, s89, 716928
    buffer_load_dwordx4 v4, s[48:51], s8 offen lds
    v_mfma_f32_32x32x16_bf16 v[16:31], v[104:107], v[220:223], v[16:31]
    s_waitcnt lgkmcnt(15)
    buffer_store_dwordx4 v[48:51], v116, s[52:55], s15 offen sc1
    v_mfma_f32_32x32x16_bf16 v[32:47], v[108:111], v[220:223], v[32:47]
    ds_read_b64_tr_b16 v[104:105], v10 offset:6144
    ds_read_b64_tr_b16 v[106:107], v10 offset:6656
    ds_read_b64_tr_b16 v[108:109], v11 offset:6144
    ds_read_b64_tr_b16 v[110:111], v11 offset:6656
    v_xor_b32 v8, 96, v6
    ds_read_b128 v[236:239], v8
    s_add_u32 m0, s90, 0
    s_add_u32 s8, s89, 917632
    buffer_load_dwordx4 v4, s[48:51], s8 offen lds
    s_waitcnt lgkmcnt(15)
    v_mfma_f32_32x32x16_bf16 v[16:31], v[80:83], v[224:227], v[16:31]
    s_cmp_lg_u32 s3, 0
    s_cbranch_scc1 Ltk2_5
    s_mov_b32 s9, 0
Ltok_6:
    v_readfirstlane_b32 s42, v139
    s_sub_u32 s8, s0, s42
    s_cmp_lt_i32 s8, 1000
    s_cselect_b32 s8, s42, 0
    s_cmp_gt_u32 s9, 64
    s_cselect_b32 s8, s42, s8
    s_cmp_lg_u32 s8, 0
    s_cbranch_scc1 Ltok_6_ok
    s_add_u32 s9, s9, 1
    s_cmp_gt_u32 s9, 20000
    s_cbranch_scc1 Ltok_6_ok
    s_sleep 8
    buffer_load_dword v139, off, s[84:87], 0 sc1
    s_waitcnt vmcnt(0)
    s_branch Ltok_6
Ltok_6_ok:
    v_mov_b32 v14, 161888
    ds_write_b32 v14, v139
Ltk2_5:
    v_mfma_f32_32x32x16_bf16 v[32:47], v[84:87], v[224:227], v[32:47]
    s_add_u32 m0, s90, 1024
    s_add_u32 s8, s89, 946304
    buffer_load_dwordx4 v4, s[48:51], s8 offen lds
    s_waitcnt lgkmcnt(10)
    v_mfma_f32_32x32x16_bf16 v[16:31], v[88:91], v[228:231], v[16:31]
    v_mfma_f32_32x32x16_bf16 v[32:47], v[92:95], v[228:231], v[32:47]
    s_waitcnt vmcnt(11) lgkmcnt(0)
    s_barrier
    v_mfma_f32_32x32x16_bf16 v[16:31], v[96:99], v[232:235], v[16:31]
    v_mov_b32 v14, 161888
    ds_read_b32 v139, v14
    v_add_u32 v10, 65536, v142
    v_add_u32 v11, 65536, v143
    v_add_u32 v6, 49152, v5
    ds_read_b64_tr_b16 v[80:81], v10 offset:0
    ds_read_b64_tr_b16 v[82:83], v10 offset:512
    ds_read_b64_tr_b16 v[84:85], v11 offset:0
    ds_read_b64_tr_b16 v[86:87], v11 offset:512
    v_xor_b32 v7, 0, v6
    ds_read_b128 v[240:243], v7
    s_add_u32 m0, s90, 16384
    s_add_u32 s8, s89, 1147008
    buffer_load_dwordx4 v4, s[48:51], s8 offen lds
    s_add_u32 m0, s90, 17408
    s_add_u32 s8, s89, 1175680
    buffer_load_dwordx4 v4, s[48:51], s8 offen lds
    v_mfma_f32_32x32x16_bf16 v[32:47], v[100:103], v[232:235], v[32:47]
    ds_read_b64_tr_b16 v[88:89], v10 offset:2048
    ds_read_b64_tr_b16 v[90:91], v10 offset:2560
    ds_read_b64_tr_b16 v[92:93], v11 offset:2048
    ds_read_b64_tr_b16 v[94:95], v11 offset:2560
    v_xor_b32 v8, 32, v6
    ds_read_b128 v[244:247], v8
    ds_read_b64_tr_b16 v[96:97], v10 offset:4096
    ds_read_b64_tr_b16 v[98:99], v10 offset:4608
    ds_read_b64_tr_b16 v[100:101], v11 offset:4096
    ds_read_b64_tr_b16 v[102:103], v11 offset:4608
    v_xor_b32 v7, 64, v6
    ds_read_b128 v[248:251], v7
    s_add_u32 m0, s90, 32768
    s_add_u32 s8, s89, 1376384
    buffer_load_dwordx4 v4, s[48:51], s8 offen lds
    v_mfma_f32_32x32x16_bf16 v[16:31], v[104:107], v[236:239], v[16:31]
    s_add_u32 m0, s90, 33792
    s_add_u32 s8, s89, 1405056
    buffer_load_dwordx4 v4, s[48:51], s8 offen lds
    v_mfma_f32_32x32x16_bf16 v[32:47], v[108:111], v[236:239], v[32:47]
    s_waitcnt lgkmcnt(15)
    v_readfirstlane_b32 s42, v139
    ds_read_b64_tr_b16 v[104:105], v10 offset:6144
    ds_read_b64_tr_b16 v[106:107], v10 offset:6656
    ds_read_b64_tr_b16 v[108:109], v11 offset:6144
    ds_read_b64_tr_b16 v[110:111], v11 offset:6656
    v_xor_b32 v8, 96, v6
    ds_read_b128 v[252:255], v8
    s_lshl_b32 s9, s2, 1
    s_add_u32 s9, s9, s4
    s_lshl_b32 s9, s9, 12
    s_add_u32 s96, s24, s9
    s_addc_u32 s97, s25, 0
    s_mov_b32 s98, 4096
    s_mov_b32 s99, 0x20000
    s_lshl_b32 s10, s5, 10
    s_mul_i32 s11, s4, 5120
    s_add_u32 s11, s11, 147456
    v_subrev_u32 v14, 256, v12
    s_add_u32 m0, s11, s10
    v_add_u32 v15, s10, v14
    buffer_load_dwordx4 v15, s[96:99], 0 offen lds
    s_waitcnt lgkmcnt(15)
    v_mfma_f32_32x32x16_bf16 v[16:31], v[80:83], v[240:243], v[16:31]
    s_add_u32 m0, s11, 4096
    v_add_u32 v15, 4096, v14
    buffer_load_dwordx4 v15, s[96:99], 0 offen lds
    v_mfma_f32_32x32x16_bf16 v[32:47], v[84:87], v[240:243], v[32:47]
    v_lshlrev_b32 v122, 3, v1
    v_and_b32 v122, 255, v122
    buffer_load_dwordx2 v[124:125], v122, s[52:55], s68 offen sc1
    s_waitcnt lgkmcnt(10)
    v_mfma_f32_32x32x16_bf16 v[16:31], v[88:91], v[244:247], v[16:31]
    s_lshl_b32 s8, s6, 11
    s_lshl_b32 s9, s3, 8
    s_add_u32 s8, s8, s9
    s_add_u32 s8, s8, 6291456
    v_and_b32 v123, 240, v12
    buffer_load_dwordx4 v[128:131], v123, s[52:55], s8 offen sc1
    v_mfma_f32_32x32x16_bf16 v[32:47], v[92:95], v[244:247], v[32:47]
    s_waitcnt vmcnt(15) lgkmcnt(0)
    s_barrier
    v_mfma_f32_32x32x16_bf16 v[16:31], v[96:99], v[248:251], v[16:31]
    v_add_u32 v10, 81920, v142
    v_add_u32 v11, 81920, v143
    ds_read_b64_tr_b16 v[80:81], v10 offset:0
    ds_read_b64_tr_b16 v[82:83], v10 offset:512
    ds_read_b64_tr_b16 v[84:85], v11 offset:0
    ds_read_b64_tr_b16 v[86:87], v11 offset:512
    s_add_u32 s8, s95, 0
    s_lshr_b32 s9, s8, 2
    s_lshl_b32 s9, s9, 2
    s_add_u32 s8, s8, s9
    s_mul_i32 s8, s8, 14336
    s_add_u32 s8, s8, s69
    s_add_u32 m0, s90, 49152
    s_add_u32 s9, s8, 0
    buffer_load_dwordx4 v9, s[76:79], s9 offen lds
    s_add_u32 m0, s90, 50176
    s_add_u32 s9, s8, 7168
    buffer_load_dwordx4 v9, s[76:79], s9 offen lds
    v_mfma_f32_32x32x16_bf16 v[32:47], v[100:103], v[248:251], v[32:47]
    ds_read_b64_tr_b16 v[88:89], v10 offset:2048
    ds_read_b64_tr_b16 v[90:91], v10 offset:2560
    ds_read_b64_tr_b16 v[92:93], v11 offset:2048
    ds_read_b64_tr_b16 v[94:95], v11 offset:2560
    ds_read_b64_tr_b16 v[96:97], v10 offset:4096
    ds_read_b64_tr_b16 v[98:99], v10 offset:4608
    ds_read_b64_tr_b16 v[100:101], v11 offset:4096
    ds_read_b64_tr_b16 v[102:103], v11 offset:4608
    v_mfma_f32_32x32x16_bf16 v[16:31], v[104:107], v[252:255], v[16:31]
    v_mfma_f32_32x32x16_bf16 v[32:47], v[108:111], v[252:255], v[32:47]
    ds_read_b64_tr_b16 v[104:105], v10 offset:6144
    ds_read_b64_tr_b16 v[106:107], v10 offset:6656
    ds_read_b64_tr_b16 v[108:109], v11 offset:6144
    ds_read_b64_tr_b16 v[110:111], v11 offset:6656
    s_waitcnt lgkmcnt(12)
    v_mfma_f32_32x32x16_bf16 v[48:63], v[80:83], v[144:147], 0
    v_mfma_f32_32x32x16_bf16 v[64:79], v[84:87], v[144:147], 0
    v_add_u32 v10, 98304, v142
    v_add_u32 v11, 98304, v143
    ds_read_b64_tr_b16 v[80:81], v10 offset:0
    ds_read_b64_tr_b16 v[82:83], v10 offset:512
    ds_read_b64_tr_b16 v[84:85], v11 offset:0
    ds_read_b64_tr_b16 v[86:87], v11 offset:512
    s_waitcnt lgkmcnt(12)
    v_mfma_f32_32x32x16_bf16 v[48:63], v[88:91], v[148:151], v[48:63]
    v_mfma_f32_32x32x16_bf16 v[64:79], v[92:95], v[148:151], v[64:79]
    ds_read_b64_tr_b16 v[88:89], v10 offset:2048
    ds_read_b64_tr_b16 v[90:91], v10 offset:2560
    ds_read_b64_tr_b16 v[92:93], v11 offset:2048
    ds_read_b64_tr_b16 v[94:95], v11 offset:2560
    s_add_u32 s8, s95, 2
    s_lshr_b32 s9, s8, 2
    s_lshl_b32 s9, s9, 2
    s_add_u32 s8, s8, s9
    s_mul_i32 s8, s8, 14336
    s_add_u32 s8, s8, s69
    s_add_u32 m0, s90, 65536
    s_add_u32 s9, s8, 0
    buffer_load_dwordx4 v9, s[76:79], s9 offen lds
    s_add_u32 m0, s90, 66560
    s_add_u32 s9, s8, 7168
    buffer_load_dwordx4 v9, s[76:79], s9 offen lds
    s_waitcnt lgkmcnt(12)
    v_mfma_f32_32x32x16_bf16 v[48:63], v[96:99], v[152:155], v[48:63]
    v_mfma_f32_32x32x16_bf16 v[64:79], v[100:103], v[152:155], v[64:79]
    ds_read_b64_tr_b16 v[96:97], v10 offset:4096
    ds_read_b64_tr_b16 v[98:99], v10 offset:4608
    ds_read_b64_tr_b16 v[100:101], v11 offset:4096
    ds_read_b64_tr_b16 v[102:103], v11 offset:4608
    s_waitcnt lgkmcnt(12)
    v_mfma_f32_32x32x16_bf16 v[48:63], v[104:107], v[156:159], v[48:63]
    v_mfma_f32_32x32x16_bf16 v[64:79], v[108:111], v[156:159], v[64:79]
    ds_read_b64_tr_b16 v[104:105], v10 offset:6144
    ds_read_b64_tr_b16 v[106:107], v10 offset:6656
    ds_read_b64_tr_b16 v[108:109], v11 offset:6144
    ds_read_b64_tr_b16 v[110:111], v11 offset:6656
    s_waitcnt lgkmcnt(12)
    v_mfma_f32_32x32x16_bf16 v[48:63], v[80:83], v[160:163], v[48:63]
    s_waitcnt vmcnt(4)
    s_mov_b32 s10, 0
Lcs_7:
    v_cmp_ne_u32 vcc, s42, v125
    v_cmp_ne_u32 s[8:9], s42, v130
    s_or_b64 vcc, vcc, s[8:9]
    s_cbranch_vccz Lcsok_8
    s_add_u32 s10, s10, 1
    s_cmp_gt_u32 s10, 20000
    s_cbranch_scc1 Lcsok_8
    s_sleep 8
    v_lshlrev_b32 v122, 3, v1
    v_and_b32 v122, 255, v122
    buffer_load_dwordx2 v[124:125], v122, s[52:55], s68 offen sc1
    s_lshl_b32 s8, s6, 11
    s_lshl_b32 s9, s3, 8
    s_add_u32 s8, s8, s9
    s_add_u32 s8, s8, 6291456
    v_and_b32 v123, 240, v12
    buffer_load_dwordx4 v[128:131], v123, s[52:55], s8 offen sc1
    s_waitcnt vmcnt(0)
    s_branch Lcs_7
Lcsok_8:
    s_lshl_b32 s8, s3, 7
    s_add_u32 s9, s8, 160768
    v_lshrrev_b32 v122, 1, v122
    v_add_u32 v122, s9, v122
    ds_write_b32 v122, v124
    s_add_u32 s9, s8, 159744
    v_lshrrev_b32 v123, 1, v123
    v_add_u32 v123, s9, v123
    ds_write_b64 v123, v[128:129]
    v_mfma_f32_32x32x16_bf16 v[64:79], v[84:87], v[160:163], v[64:79]
    s_waitcnt lgkmcnt(10)
    v_mfma_f32_32x32x16_bf16 v[48:63], v[88:91], v[164:167], v[48:63]
    v_mfma_f32_32x32x16_bf16 v[64:79], v[92:95], v[164:167], v[64:79]
    s_waitcnt vmcnt(14) lgkmcnt(0)
    s_barrier
    v_mfma_f32_32x32x16_bf16 v[48:63], v[96:99], v[168:171], v[48:63]
    v_and_b32 v14, 31, v1
    s_and_b32 s8, s3, 3
    s_lshl_b32 s8, s8, 8
    s_add_u32 s8, s8, 159744
    v_lshl_add_u32 v14, v14, 3, s8
    ds_read_b64 v[136:137], v14
    v_lshrrev_b32 v138, 5, v1
    s_lshr_b32 s8, s3, 2
    s_lshl_b32 s8, s8, 7
    s_add_u32 s8, s8, 160768
    v_lshl_add_u32 v138, v138, 4, s8
    v_add_u32 v10, 114688, v142
    v_add_u32 v11, 114688, v143
    ds_read_b64_tr_b16 v[80:81], v10 offset:0
    ds_read_b64_tr_b16 v[82:83], v10 offset:512
    ds_read_b64_tr_b16 v[84:85], v11 offset:0
    ds_read_b64_tr_b16 v[86:87], v11 offset:512
    s_add_u32 s8, s95, 4
    s_lshr_b32 s9, s8, 2
    s_lshl_b32 s9, s9, 2
    s_add_u32 s8, s8, s9
    s_mul_i32 s8, s8, 14336
    s_add_u32 s8, s8, s69
    s_add_u32 m0, s90, 81920
    s_add_u32 s9, s8, 0
    buffer_load_dwordx4 v9, s[76:79], s9 offen lds
    s_add_u32 m0, s90, 82944
    s_add_u32 s9, s8, 7168
    buffer_load_dwordx4 v9, s[76:79], s9 offen lds
    v_mfma_f32_32x32x16_bf16 v[64:79], v[100:103], v[168:171], v[64:79]
    s_cmp_lg_u32 s3, 0
    s_cbranch_scc1 Lw0_9
    s_lshl_b32 s8, s43, 2
    s_add_u32 s8, s8, 6488064
    v_mov_b32 v14, s42
    v_and_b32 v15, 3, v1
    v_lshlrev_b32 v15, 10, v15
    buffer_store_dword v14, v15, s[52:55], s8 offen sc1
Lw0_9:
    ds_read_b128 v[112:115], v138 offset:0
    ds_read_b128 v[116:119], v138 offset:32
    ds_read_b128 v[120:123], v138 offset:512
    ds_read_b128 v[124:127], v138 offset:544
    ds_read_b64_tr_b16 v[88:89], v10 offset:2048
    ds_read_b64_tr_b16 v[90:91], v10 offset:2560
    ds_read_b64_tr_b16 v[92:93], v11 offset:2048
    ds_read_b64_tr_b16 v[94:95], v11 offset:2560
    ds_read_b64_tr_b16 v[96:97], v10 offset:4096
    ds_read_b64_tr_b16 v[98:99], v10 offset:4608
    ds_read_b64_tr_b16 v[100:101], v11 offset:4096
    ds_read_b64_tr_b16 v[102:103], v11 offset:4608
    v_mfma_f32_32x32x16_bf16 v[48:63], v[104:107], v[172:175], v[48:63]
    v_mfma_f32_32x32x16_bf16 v[64:79], v[108:111], v[172:175], v[64:79]
    s_waitcnt lgkmcnt(8)
    ds_read_b64_tr_b16 v[104:105], v10 offset:6144
    ds_read_b64_tr_b16 v[106:107], v10 offset:6656
    ds_read_b64_tr_b16 v[108:109], v11 offset:6144
    ds_read_b64_tr_b16 v[110:111], v11 offset:6656
    v_mul_f32 v137, 0xbfb8aa3b, v137
    v_fma_f32 v16, -v136, v112, v16
    v_fma_f32 v17, -v136, v113, v17
    v_fma_f32 v18, -v136, v114, v18
    v_fma_f32 v19, -v136, v115, v19
    v_fma_f32 v20, -v136, v116, v20
    v_mfma_f32_32x32x16_bf16 v[48:63], v[80:83], v[176:179], v[48:63]
    v_fma_f32 v21, -v136, v117, v21
    v_fma_f32 v22, -v136, v118, v22
    v_fma_f32 v23, -v136, v119, v23
    v_mul_f32 v128, v137, v16
    v_mul_f32 v129, v137, v17
    v_mfma_f32_32x32x16_bf16 v[64:79], v[84:87], v[176:179], v[64:79]
    v_add_u32 v10, 131072, v142
    v_add_u32 v11, 131072, v143
    ds_read_b64_tr_b16 v[80:81], v10 offset:0
    ds_read_b64_tr_b16 v[82:83], v10 offset:512
    ds_read_b64_tr_b16 v[84:85], v11 offset:0
    ds_read_b64_tr_b16 v[86:87], v11 offset:512
    v_mul_f32 v130, v137, v18
    v_mul_f32 v131, v137, v19
    v_mul_f32 v132, v137, v20
    v_mul_f32 v133, v137, v21
    v_mul_f32 v134, v137, v22
    v_mul_f32 v135, v137, v23
    s_waitcnt lgkmcnt(12)
    v_mfma_f32_32x32x16_bf16 v[48:63], v[88:91], v[180:183], v[48:63]
    v_exp_f32 v128, v128
    v_fma_f32 v24, -v136, v120, v24
    v_exp_f32 v129, v129
    v_fma_f32 v25, -v136, v121, v25
    v_exp_f32 v130, v130
    v_mfma_f32_32x32x16_bf16 v[64:79], v[92:95], v[180:183], v[64:79]
    ds_read_b64_tr_b16 v[88:89], v10 offset:2048
    ds_read_b64_tr_b16 v[90:91], v10 offset:2560
    ds_read_b64_tr_b16 v[92:93], v11 offset:2048
    ds_read_b64_tr_b16 v[94:95], v11 offset:2560
    s_add_u32 s8, s95, 6
    s_lshr_b32 s9, s8, 2
    s_lshl_b32 s9, s9, 2
    s_add_u32 s8, s8, s9
    s_mul_i32 s8, s8, 14336
    s_add_u32 s8, s8, s69
    s_add_u32 m0, s90, 98304
    s_add_u32 s9, s8, 0
    buffer_load_dwordx4 v9, s[76:79], s9 offen lds
    s_add_u32 m0, s90, 99328
    s_add_u32 s9, s8, 7168
    buffer_load_dwordx4 v9, s[76:79], s9 offen lds
    v_fma_f32 v26, -v136, v122, v26
    v_exp_f32 v131, v131
    v_fma_f32 v27, -v136, v123, v27
    v_exp_f32 v132, v132
    v_fma_f32 v28, -v136, v124, v28
    s_waitcnt lgkmcnt(12)
    v_mfma_f32_32x32x16_bf16 v[48:63], v[96:99], v[184:187], v[48:63]
    v_exp_f32 v133, v133
    v_fma_f32 v29, -v136, v125, v29
    v_exp_f32 v134, v134
    v_fma_f32 v30, -v136, v126, v30
    v_exp_f32 v135, v135
    v_fma_f32 v31, -v136, v127, v31
    v_mfma_f32_32x32x16_bf16 v[64:79], v[100:103], v[184:187], v[64:79]
    ds_read_b64_tr_b16 v[96:97], v10 offset:4096
    ds_read_b64_tr_b16 v[98:99], v10 offset:4608
    ds_read_b64_tr_b16 v[100:101], v11 offset:4096
    ds_read_b64_tr_b16 v[102:103], v11 offset:4608
    v_add_f32 v128, 1.0, v128
    v_add_f32 v129, 1.0, v129
    v_add_f32 v130, 1.0, v130
    v_add_f32 v131, 1.0, v131
    v_add_f32 v132, 1.0, v132
    s_waitcnt lgkmcnt(12)
    v_mfma_f32_32x32x16_bf16 v[48:63], v[104:107], v[188:191], v[48:63]
    v_add_f32 v133, 1.0, v133
    v_add_f32 v134, 1.0, v134
    v_add_f32 v135, 1.0, v135
    v_rcp_f32 v128, v128
    v_mul_f32 v16, v16, v24
    v_rcp_f32 v129, v129
    v_mfma_f32_32x32x16_bf16 v[64:79], v[108:111], v[188:191], v[64:79]
    ds_read_b64_tr_b16 v[104:105], v10 offset:6144
    ds_read_b64_tr_b16 v[106:107], v10 offset:6656
    ds_read_b64_tr_b16 v[108:109], v11 offset:6144
    ds_read_b64_tr_b16 v[110:111], v11 offset:6656
    v_mul_f32 v17, v17, v25
    v_rcp_f32 v130, v130
    v_mul_f32 v18, v18, v26
    v_rcp_f32 v131, v131
    v_mul_f32 v19, v19, v27
    s_waitcnt lgkmcnt(12)
    v_mfma_f32_32x32x16_bf16 v[48:63], v[80:83], v[192:195], v[48:63]
    v_rcp_f32 v132, v132
    v_mul_f32 v20, v20, v28
    v_rcp_f32 v133, v133
    v_mul_f32 v21, v21, v29
    v_rcp_f32 v134, v134
    v_mfma_f32_32x32x16_bf16 v[64:79], v[84:87], v[192:195], v[64:79]
    v_mul_f32 v22, v22, v30
    v_rcp_f32 v135, v135
    v_mul_f32 v23, v23, v31
    v_mul_f32 v16, v16, v128
    v_mul_f32 v17, v17, v129
    v_mul_f32 v18, v18, v130
    s_waitcnt lgkmcnt(8)
    v_mfma_f32_32x32x16_bf16 v[48:63], v[88:91], v[196:199], v[48:63]
    v_mul_f32 v19, v19, v131
    v_mul_f32 v20, v20, v132
    v_mul_f32 v21, v21, v133
    v_mul_f32 v22, v22, v134
    v_mul_f32 v23, v23, v135
    v_mfma_f32_32x32x16_bf16 v[64:79], v[92:95], v[196:199], v[64:79]
    v_cvt_pk_bf16_f32 v24, v16, v17
    v_cvt_pk_bf16_f32 v25, v18, v19
    v_cvt_pk_bf16_f32 v26, v20, v21
    v_cvt_pk_bf16_f32 v27, v22, v23
    s_add_u32 s8, s70, 0
    buffer_store_dwordx4 v[24:27], v12, s[52:55], s8 offen offset:0 sc1
    s_waitcnt vmcnt(15) lgkmcnt(0)
    s_barrier
    s_lshr_b32 s94, s2, 5
    s_lshl_b32 s94, s94, 7
    s_and_b32 s8, s2, 3
    s_lshl_b32 s8, s8, 10
    s_add_u32 s94, s94, s8
    s_add_u32 s94, s94, 6488064
    v_mfma_f32_32x32x16_bf16 v[48:63], v[96:99], v[200:203], v[48:63]
    ds_read_b128 v[112:115], v138 offset:64
    ds_read_b128 v[116:119], v138 offset:96
    ds_read_b128 v[120:123], v138 offset:576
    ds_read_b128 v[124:127], v138 offset:608
    v_add_u32 v10, 0, v142
    v_add_u32 v11, 0, v143
    ds_read_b64_tr_b16 v[80:81], v10 offset:0
    ds_read_b64_tr_b16 v[82:83], v10 offset:512
    ds_read_b64_tr_b16 v[84:85], v11 offset:0
    ds_read_b64_tr_b16 v[86:87], v11 offset:512
    v_mfma_f32_32x32x16_bf16 v[64:79], v[100:103], v[200:203], v[64:79]
    ds_read_b64_tr_b16 v[88:89], v10 offset:2048
    ds_read_b64_tr_b16 v[90:91], v10 offset:2560
    ds_read_b64_tr_b16 v[92:93], v11 offset:2048
    ds_read_b64_tr_b16 v[94:95], v11 offset:2560
    ds_read_b64_tr_b16 v[96:97], v10 offset:4096
    ds_read_b64_tr_b16 v[98:99], v10 offset:4608
    ds_read_b64_tr_b16 v[100:101], v11 offset:4096
    ds_read_b64_tr_b16 v[102:103], v11 offset:4608
    v_mfma_f32_32x32x16_bf16 v[48:63], v[104:107], v[204:207], v[48:63]
    s_waitcnt lgkmcnt(12)
    v_fma_f32 v32, -v136, v112, v32
    v_fma_f32 v33, -v136, v113, v33
    v_fma_f32 v34, -v136, v114, v34
    v_fma_f32 v35, -v136, v115, v35
    v_fma_f32 v36, -v136, v116, v36
    v_fma_f32 v37, -v136, v117, v37
    v_fma_f32 v38, -v136, v118, v38
    v_mfma_f32_32x32x16_bf16 v[64:79], v[108:111], v[204:207], v[64:79]
    ds_read_b64_tr_b16 v[104:105], v10 offset:6144
    ds_read_b64_tr_b16 v[106:107], v10 offset:6656
    ds_read_b64_tr_b16 v[108:109], v11 offset:6144
    ds_read_b64_tr_b16 v[110:111], v11 offset:6656
    v_fma_f32 v39, -v136, v119, v39
    v_mul_f32 v128, v137, v32
    v_mul_f32 v129, v137, v33
    v_mul_f32 v130, v137, v34
    v_mul_f32 v131, v137, v35
    v_mul_f32 v132, v137, v36
    v_mul_f32 v133, v137, v37
    s_waitcnt lgkmcnt(12)
    v_mfma_f32_32x32x16_bf16 v[48:63], v[80:83], v[208:211], v[48:63]
    v_mul_f32 v134, v137, v38
    v_mul_f32 v135, v137, v39
    v_exp_f32 v128, v128
    v_fma_f32 v40, -v136, v120, v40
    v_exp_f32 v129, v129
    v_fma_f32 v41, -v136, v121, v41
    v_exp_f32 v130, v130
    v_mfma_f32_32x32x16_bf16 v[64:79], v[84:87], v[208:211], v[64:79]
    v_add_u32 v10, 16384, v142
    v_add_u32 v11, 16384, v143
    ds_read_b64_tr_b16 v[80:81], v10 offset:0
    ds_read_b64_tr_b16 v[82:83], v10 offset:512
    ds_read_b64_tr_b16 v[84:85], v11 offset:0
    ds_read_b64_tr_b16 v[86:87], v11 offset:512
    v_fma_f32 v42, -v136, v122, v42
    v_exp_f32 v131, v131
    v_fma_f32 v43, -v136, v123, v43
    v_exp_f32 v132, v132
    v_fma_f32 v44, -v136, v124, v44
    v_exp_f32 v133, v133
    v_fma_f32 v45, -v136, v125, v45
    s_waitcnt lgkmcnt(12)
    v_mfma_f32_32x32x16_bf16 v[48:63], v[88:91], v[212:215], v[48:63]
    v_exp_f32 v134, v134
    v_fma_f32 v46, -v136, v126, v46
    v_exp_f32 v135, v135
    v_fma_f32 v47, -v136, v127, v47
    v_add_f32 v128, 1.0, v128
    v_add_f32 v129, 1.0, v129
    v_add_f32 v130, 1.0, v130
    v_mfma_f32_32x32x16_bf16 v[64:79], v[92:95], v[212:215], v[64:79]
    ds_read_b64_tr_b16 v[88:89], v10 offset:2048
    ds_read_b64_tr_b16 v[90:91], v10 offset:2560
    ds_read_b64_tr_b16 v[92:93], v11 offset:2048
    ds_read_b64_tr_b16 v[94:95], v11 offset:2560
    v_add_f32 v131, 1.0, v131
    v_add_f32 v132, 1.0, v132
    v_add_f32 v133, 1.0, v133
    v_add_f32 v134, 1.0, v134
    v_add_f32 v135, 1.0, v135
    v_rcp_f32 v128, v128
    v_mul_f32 v32, v32, v40
    s_waitcnt lgkmcnt(12)
    v_mfma_f32_32x32x16_bf16 v[48:63], v[96:99], v[216:219], v[48:63]
    v_rcp_f32 v129, v129
    v_mul_f32 v33, v33, v41
    v_rcp_f32 v130, v130
    v_mul_f32 v34, v34, v42
    v_rcp_f32 v131, v131
    v_mul_f32 v35, v35, v43
    v_rcp_f32 v132, v132
    v_mfma_f32_32x32x16_bf16 v[64:79], v[100:103], v[216:219], v[64:79]
    ds_read_b64_tr_b16 v[96:97], v10 offset:4096
    ds_read_b64_tr_b16 v[98:99], v10 offset:4608
    ds_read_b64_tr_b16 v[100:101], v11 offset:4096
    ds_read_b64_tr_b16 v[102:103], v11 offset:4608
    v_mul_f32 v36, v36, v44
    v_rcp_f32 v133, v133
    v_mul_f32 v37, v37, v45
    v_rcp_f32 v134, v134
    v_mul_f32 v38, v38, v46
    v_rcp_f32 v135, v135
    v_mul_f32 v39, v39, v47
    s_waitcnt lgkmcnt(12)
    v_mfma_f32_32x32x16_bf16 v[48:63], v[104:107], v[220:223], v[48:63]
    v_mul_f32 v32, v32, v128
    v_mul_f32 v33, v33, v129
    v_mul_f32 v34, v34, v130
    v_mul_f32 v35, v35, v131
    v_mul_f32 v36, v36, v132
    v_mul_f32 v37, v37, v133
    v_mul_f32 v38, v38, v134
    v_mfma_f32_32x32x16_bf16 v[64:79], v[108:111], v[220:223], v[64:79]
    ds_read_b64_tr_b16 v[104:105], v10 offset:6144
    ds_read_b64_tr_b16 v[106:107], v10 offset:6656
    ds_read_b64_tr_b16 v[108:109], v11 offset:6144
    ds_read_b64_tr_b16 v[110:111], v11 offset:6656
    v_mul_f32 v39, v39, v135
    v_cvt_pk_bf16_f32 v40, v32, v33
    v_cvt_pk_bf16_f32 v41, v34, v35
    v_cvt_pk_bf16_f32 v42, v36, v37
    v_cvt_pk_bf16_f32 v43, v38, v39
    s_add_u32 s8, s70, 0
    buffer_store_dwordx4 v[40:43], v12, s[52:55], s8 offen offset:1024 sc1
    s_waitcnt lgkmcnt(12)
    v_mfma_f32_32x32x16_bf16 v[48:63], v[80:83], v[224:227], v[48:63]
    v_mfma_f32_32x32x16_bf16 v[64:79], v[84:87], v[224:227], v[64:79]
    s_waitcnt lgkmcnt(8)
    v_mfma_f32_32x32x16_bf16 v[48:63], v[88:91], v[228:231], v[48:63]
    v_mfma_f32_32x32x16_bf16 v[64:79], v[92:95], v[228:231], v[64:79]
    s_waitcnt vmcnt(0) lgkmcnt(0)
    s_barrier
    s_add_u32 s8, s71, 0
    v_mov_b32 v14, s42
    buffer_store_dword v14, off, s[52:55], s8 sc1
    s_sub_u32 s98, s3, 4
    s_lshl_b32 s99, s98, 12
    s_mul_i32 s98, s98, 14
    v_mfma_f32_32x32x16_bf16 v[48:63], v[96:99], v[232:235], v[48:63]
    v_add_u32 v10, 32768, v142
    v_add_u32 v11, 32768, v143
    ds_read_b64_tr_b16 v[80:81], v10 offset:0
    ds_read_b64_tr_b16 v[82:83], v10 offset:512
    ds_read_b64_tr_b16 v[84:85], v11 offset:0
    ds_read_b64_tr_b16 v[86:87], v11 offset:512
    s_cmp_lg_u32 s3, 0
    s_cbranch_scc1 Lw0_10
    v_and_b32 v14, 124, v13
    buffer_load_dword v15, v14, s[52:55], s94 offen sc1
Lw0_10:
    v_mfma_f32_32x32x16_bf16 v[64:79], v[100:103], v[232:235], v[64:79]
    ds_read_b64_tr_b16 v[88:89], v10 offset:2048
    ds_read_b64_tr_b16 v[90:91], v10 offset:2560
    ds_read_b64_tr_b16 v[92:93], v11 offset:2048
    ds_read_b64_tr_b16 v[94:95], v11 offset:2560
    ds_read_b64_tr_b16 v[96:97], v10 offset:4096
    ds_read_b64_tr_b16 v[98:99], v10 offset:4608
    ds_read_b64_tr_b16 v[100:101], v11 offset:4096
    ds_read_b64_tr_b16 v[102:103], v11 offset:4608
    v_mov_b32 v112, 0
    v_mov_b32 v113, 0
    v_mov_b32 v114, 0
    v_mov_b32 v115, 0
    ds_write_b128 v0, v[112:115]
    v_mfma_f32_32x32x16_bf16 v[48:63], v[104:107], v[236:239], v[48:63]
    v_mov_b32 v116, 161920
    ds_write_b32 v116, v112
    v_mfma_f32_32x32x16_bf16 v[64:79], v[108:111], v[236:239], v[64:79]
    ds_read_b64_tr_b16 v[104:105], v10 offset:6144
    ds_read_b64_tr_b16 v[106:107], v10 offset:6656
    ds_read_b64_tr_b16 v[108:109], v11 offset:6144
    ds_read_b64_tr_b16 v[110:111], v11 offset:6656
    s_cmp_lt_u32 s3, 4
    s_cbranch_scc1 Lz_11
    s_add_u32 s8, s98, 8
    s_lshr_b32 s9, s8, 2
    s_lshl_b32 s9, s9, 2
    s_add_u32 s8, s8, s9
    s_mul_i32 s8, s8, 14336
    s_add_u32 s8, s8, s69
    s_add_u32 m0, s99, 0
    s_add_u32 s9, s8, 0
    buffer_load_dwordx4 v9, s[76:79], s9 offen lds
    s_add_u32 m0, s99, 1024
    s_add_u32 s9, s8, 7168
    buffer_load_dwordx4 v9, s[76:79], s9 offen lds
Lz_11:
    s_waitcnt lgkmcnt(14)
    v_mfma_f32_32x32x16_bf16 v[48:63], v[80:83], v[240:243], v[48:63]
    s_cmp_lt_u32 s3, 4
    s_cbranch_scc1 Lz_12
    s_add_u32 s8, s98, 9
    s_lshr_b32 s9, s8, 2
    s_lshl_b32 s9, s9, 2
    s_add_u32 s8, s8, s9
    s_mul_i32 s8, s8, 14336
    s_add_u32 s8, s8, s69
    s_add_u32 m0, s99, 2048
    s_add_u32 s9, s8, 0
    buffer_load_dwordx4 v9, s[76:79], s9 offen lds
    s_add_u32 m0, s99, 3072
    s_add_u32 s9, s8, 7168
    buffer_load_dwordx4 v9, s[76:79], s9 offen lds
Lz_12:
    v_mfma_f32_32x32x16_bf16 v[64:79], v[84:87], v[240:243], v[64:79]
    s_cmp_lt_u32 s3, 4
    s_cbranch_scc1 Lz_13
    s_add_u32 s8, s98, 10
    s_lshr_b32 s9, s8, 2
    s_lshl_b32 s9, s9, 2
    s_add_u32 s8, s8, s9
    s_mul_i32 s8, s8, 14336
    s_add_u32 s8, s8, s69
    s_add_u32 m0, s99, 16384
    s_add_u32 s9, s8, 0
    buffer_load_dwordx4 v9, s[76:79], s9 offen lds
    s_add_u32 m0, s99, 17408
    s_add_u32 s9, s8, 7168
    buffer_load_dwordx4 v9, s[76:79], s9 offen lds
Lz_13:
    s_waitcnt lgkmcnt(10)
    v_mfma_f32_32x32x16_bf16 v[48:63], v[88:91], v[244:247], v[48:63]
    s_cmp_lt_u32 s3, 4
    s_cbranch_scc1 Lz_14
    s_add_u32 s8, s98, 11
    s_lshr_b32 s9, s8, 2
    s_lshl_b32 s9, s9, 2
    s_add_u32 s8, s8, s9
    s_mul_i32 s8, s8, 14336
    s_add_u32 s8, s8, s69
    s_add_u32 m0, s99, 18432
    s_add_u32 s9, s8, 0
    buffer_load_dwordx4 v9, s[76:79], s9 offen lds
    s_add_u32 m0, s99, 19456
    s_add_u32 s9, s8, 7168
    buffer_load_dwordx4 v9, s[76:79], s9 offen lds
Lz_14:
    v_mfma_f32_32x32x16_bf16 v[64:79], v[92:95], v[244:247], v[64:79]
    s_cmp_lg_u32 s3, 0
    s_cbranch_scc1 Lpk2_15
    s_waitcnt vmcnt(0)
    s_mov_b32 s9, 0
Lchk_16:
    v_cmp_ne_u32 vcc, s42, v15
    s_and_b32 s8, vcc_lo, 0xffffffff
    s_cmp_eq_u32 s8, 0
    s_cbranch_scc1 Lok_17
    s_add_u32 s9, s9, 1
    s_cmp_gt_u32 s9, 20000
    s_cbranch_scc1 Lok_17
    s_sleep 8
    buffer_load_dword v15, v14, s[52:55], s94 offen sc1
    s_waitcnt vmcnt(0)
    s_branch Lchk_16
Lok_17:
Lpk2_15:
    s_waitcnt lgkmcnt(0)
    s_barrier
    v_mfma_f32_32x32x16_bf16 v[48:63], v[96:99], v[248:251], v[48:63]
    v_mfma_f32_32x32x16_bf16 v[64:79], v[100:103], v[248:251], v[64:79]
    v_mfma_f32_32x32x16_bf16 v[48:63], v[104:107], v[252:255], v[48:63]
    v_mfma_f32_32x32x16_bf16 v[64:79], v[108:111], v[252:255], v[64:79]
    v_lshrrev_b32 v2, 5, v1
    v_bfe_u32 v3, v1, 2, 2
    v_lshl_add_u32 v5, v2, 2, v3
    v_lshlrev_b32 v5, 7, v5
    v_bfe_u32 v3, v1, 4, 1
    v_lshl_add_u32 v5, v3, 5, v5
    v_and_b32 v3, 3, v1
    v_lshl_add_u32 v5, v3, 3, v5
    v_bfe_u32 v3, v1, 3, 1
    v_lshl_add_u32 v5, v3, 6, v5
    v_add_u32 v5, s99, v5
    v_xor_b32 v6, 64, v5
    v_add_u32 v7, 65536, v5
    v_add_u32 v8, 65536, v6
    ds_read_b128 v[16:19], v138 offset:256
    ds_read_b128 v[20:23], v138 offset:288
    ds_read_b128 v[24:27], v138 offset:768
    ds_read_b128 v[28:31], v138 offset:800
    ds_read_b128 v[112:115], v138 offset:320
    ds_read_b128 v[116:119], v138 offset:352
    ds_read_b128 v[120:123], v138 offset:832
    ds_read_b128 v[124:127], v138 offset:864
    s_cmp_lt_u32 s3, 4
    s_cbranch_scc1 Lu1_19
    ds_read_b64_tr_b16 v[144:145], v5 offset:49152
    ds_read_b64_tr_b16 v[146:147], v5 offset:50176
    ds_read_b64_tr_b16 v[148:149], v6 offset:49152
    ds_read_b64_tr_b16 v[150:151], v6 offset:50176
    ds_read_b64_tr_b16 v[152:153], v5 offset:51200
    ds_read_b64_tr_b16 v[154:155], v5 offset:52224
    ds_read_b64_tr_b16 v[156:157], v6 offset:51200
    ds_read_b64_tr_b16 v[158:159], v6 offset:52224
    ds_read_b64_tr_b16 v[160:161], v7 offset:0
    ds_read_b64_tr_b16 v[162:163], v7 offset:1024
    ds_read_b64_tr_b16 v[164:165], v8 offset:0
    ds_read_b64_tr_b16 v[166:167], v8 offset:1024
    ds_read_b64_tr_b16 v[168:169], v7 offset:2048
    ds_read_b64_tr_b16 v[170:171], v7 offset:3072
    ds_read_b64_tr_b16 v[172:173], v8 offset:2048
    ds_read_b64_tr_b16 v[174:175], v8 offset:3072
    ds_read_b64_tr_b16 v[176:177], v7 offset:16384
    ds_read_b64_tr_b16 v[178:179], v7 offset:17408
    ds_read_b64_tr_b16 v[180:181], v8 offset:16384
    ds_read_b64_tr_b16 v[182:183], v8 offset:17408
    ds_read_b64_tr_b16 v[184:185], v7 offset:18432
    ds_read_b64_tr_b16 v[186:187], v7 offset:19456
    ds_read_b64_tr_b16 v[188:189], v8 offset:18432
    ds_read_b64_tr_b16 v[190:191], v8 offset:19456
    ds_read_b64_tr_b16 v[192:193], v7 offset:32768
    ds_read_b64_tr_b16 v[194:195], v7 offset:33792
    ds_read_b64_tr_b16 v[196:197], v8 offset:32768
    ds_read_b64_tr_b16 v[198:199], v8 offset:33792
    ds_read_b64_tr_b16 v[200:201], v7 offset:34816
    ds_read_b64_tr_b16 v[202:203], v7 offset:35840
    ds_read_b64_tr_b16 v[204:205], v8 offset:34816
    ds_read_b64_tr_b16 v[206:207], v8 offset:35840
    s_add_u32 s8, s98, 12
    s_lshr_b32 s9, s8, 2
    s_lshl_b32 s9, s9, 2
    s_add_u32 s8, s8, s9
    s_mul_i32 s8, s8, 14336
    s_add_u32 s8, s8, s69
    s_add_u32 m0, s99, 32768
    s_add_u32 s9, s8, 0
    buffer_load_dwordx4 v9, s[76:79], s9 offen lds
    s_add_u32 m0, s99, 33792
    s_add_u32 s9, s8, 7168
    buffer_load_dwordx4 v9, s[76:79], s9 offen lds
    s_add_u32 s8, s98, 13
    s_lshr_b32 s9, s8, 2
    s_lshl_b32 s9, s9, 2
    s_add_u32 s8, s8, s9
    s_mul_i32 s8, s8, 14336
    s_add_u32 s8, s8, s69
    s_add_u32 m0, s99, 34816
    s_add_u32 s9, s8, 0
    buffer_load_dwordx4 v9, s[76:79], s9 offen lds
    s_add_u32 m0, s99, 35840
    s_add_u32 s9, s8, 7168
    buffer_load_dwordx4 v9, s[76:79], s9 offen lds
    s_branch Lu2_18
Lu1_19:
    s_lshl_b32 s9, s2, 1
    s_add_u32 s9, s9, s5
    s_lshl_b32 s9, s9, 12
    s_add_u32 s96, s40, s9
    s_addc_u32 s97, s41, 0
    s_mov_b32 s98, 4096
    s_mov_b32 s99, 0x20000
    s_mul_i32 s10, s3, 6144
    s_add_u32 s10, s10, 114688
    s_lshl_b32 s9, s4, 2
    s_sub_u32 s11, 4, s9
    v_lshrrev_b32 v14, 4, v1
    v_lshlrev_b32 v14, 4, v14
    v_xor_b32 v14, v14, v12
    v_add_u32 v14, s11, v14
    s_add_u32 m0, s10, 0
    v_xor_b32 v15, 0, v14
    v_add_u32 v15, 0, v15
    buffer_load_dwordx4 v15, s[96:99], 0 offen sc1 lds
    s_add_u32 m0, s10, 1024
    v_xor_b32 v15, 64, v14
    v_add_u32 v15, 1024, v15
    buffer_load_dwordx4 v15, s[96:99], 0 offen sc1 lds
    s_add_u32 m0, s10, 2048
    v_xor_b32 v15, 128, v14
    v_add_u32 v15, 2048, v15
    buffer_load_dwordx4 v15, s[96:99], 0 offen sc1 lds
    s_add_u32 m0, s10, 3072
    v_xor_b32 v15, 192, v14
    v_add_u32 v15, 3072, v15
    buffer_load_dwordx4 v15, s[96:99], 0 offen sc1 lds
    s_lshl_b32 s10, s2, 1
    s_add_u32 s10, s10, s5
    s_lshl_b32 s10, s10, 1
    buffer_load_ushort v0, off, s[72:75], s10
Lu2_18:
    s_setprio 2
    s_waitcnt lgkmcnt(0)
    v_pk_fma_f32 v[48:49], v[136:137], v[16:17], v[48:49] op_sel_hi:[0,1,1] neg_lo:[1,0,0] neg_hi:[1,0,0]
    v_pk_fma_f32 v[50:51], v[136:137], v[18:19], v[50:51] op_sel_hi:[0,1,1] neg_lo:[1,0,0] neg_hi:[1,0,0]
    v_pk_fma_f32 v[52:53], v[136:137], v[20:21], v[52:53] op_sel_hi:[0,1,1] neg_lo:[1,0,0] neg_hi:[1,0,0]
    v_pk_fma_f32 v[54:55], v[136:137], v[22:23], v[54:55] op_sel_hi:[0,1,1] neg_lo:[1,0,0] neg_hi:[1,0,0]
    v_pk_mul_f32 v[32:33], v[136:137], v[48:49] op_sel:[1,0] op_sel_hi:[1,1]
    v_pk_mul_f32 v[34:35], v[136:137], v[50:51] op_sel:[1,0] op_sel_hi:[1,1]
    v_pk_mul_f32 v[36:37], v[136:137], v[52:53] op_sel:[1,0] op_sel_hi:[1,1]
    v_pk_mul_f32 v[38:39], v[136:137], v[54:55] op_sel:[1,0] op_sel_hi:[1,1]
    v_exp_f32 v32, v32
    v_exp_f32 v33, v33
    v_pk_fma_f32 v[56:57], v[136:137], v[24:25], v[56:57] op_sel_hi:[0,1,1] neg_lo:[1,0,0] neg_hi:[1,0,0]
    v_exp_f32 v34, v34
    v_exp_f32 v35, v35
    v_pk_fma_f32 v[58:59], v[136:137], v[26:27], v[58:59] op_sel_hi:[0,1,1] neg_lo:[1,0,0] neg_hi:[1,0,0]
    v_exp_f32 v36, v36
    v_exp_f32 v37, v37
    v_pk_fma_f32 v[60:61], v[136:137], v[28:29], v[60:61] op_sel_hi:[0,1,1] neg_lo:[1,0,0] neg_hi:[1,0,0]
    v_exp_f32 v38, v38
    v_exp_f32 v39, v39
    v_pk_fma_f32 v[62:63], v[136:137], v[30:31], v[62:63] op_sel_hi:[0,1,1] neg_lo:[1,0,0] neg_hi:[1,0,0]
    v_pk_add_f32 v[32:33], v[32:33], 1.0 op_sel_hi:[1,0]
    v_pk_add_f32 v[34:35], v[34:35], 1.0 op_sel_hi:[1,0]
    v_pk_add_f32 v[36:37], v[36:37], 1.0 op_sel_hi:[1,0]
    v_pk_add_f32 v[38:39], v[38:39], 1.0 op_sel_hi:[1,0]
    v_rcp_f32 v32, v32
    v_rcp_f32 v33, v33
    v_pk_mul_f32 v[48:49], v[48:49], v[56:57]
    v_rcp_f32 v34, v34
    v_rcp_f32 v35, v35
    v_pk_mul_f32 v[50:51], v[50:51], v[58:59]
    v_rcp_f32 v36, v36
    v_rcp_f32 v37, v37
    v_pk_mul_f32 v[52:53], v[52:53], v[60:61]
    v_rcp_f32 v38, v38
    v_rcp_f32 v39, v39
    v_pk_mul_f32 v[54:55], v[54:55], v[62:63]
    v_pk_mul_f32 v[48:49], v[48:49], v[32:33]
    v_pk_mul_f32 v[50:51], v[50:51], v[34:35]
    v_pk_mul_f32 v[52:53], v[52:53], v[36:37]
    v_pk_mul_f32 v[54:55], v[54:55], v[38:39]
    v_cvt_pk_bf16_f32 v56, v48, v49
    v_cvt_pk_bf16_f32 v57, v50, v51
    v_cvt_pk_bf16_f32 v58, v52, v53
    v_cvt_pk_bf16_f32 v59, v54, v55
    s_add_u32 s8, s70, 57344
    buffer_store_dwordx4 v[56:59], v12, s[52:55], s8 offen offset:0 sc1
    v_pk_fma_f32 v[64:65], v[136:137], v[112:113], v[64:65] op_sel_hi:[0,1,1] neg_lo:[1,0,0] neg_hi:[1,0,0]
    v_pk_fma_f32 v[66:67], v[136:137], v[114:115], v[66:67] op_sel_hi:[0,1,1] neg_lo:[1,0,0] neg_hi:[1,0,0]
    v_pk_fma_f32 v[68:69], v[136:137], v[116:117], v[68:69] op_sel_hi:[0,1,1] neg_lo:[1,0,0] neg_hi:[1,0,0]
    v_pk_fma_f32 v[70:71], v[136:137], v[118:119], v[70:71] op_sel_hi:[0,1,1] neg_lo:[1,0,0] neg_hi:[1,0,0]
    v_pk_mul_f32 v[128:129], v[136:137], v[64:65] op_sel:[1,0] op_sel_hi:[1,1]
    v_pk_mul_f32 v[130:131], v[136:137], v[66:67] op_sel:[1,0] op_sel_hi:[1,1]
    v_pk_mul_f32 v[132:133], v[136:137], v[68:69] op_sel:[1,0] op_sel_hi:[1,1]
    v_pk_mul_f32 v[134:135], v[136:137], v[70:71] op_sel:[1,0] op_sel_hi:[1,1]
    v_exp_f32 v128, v128
    v_exp_f32 v129, v129
    v_pk_fma_f32 v[72:73], v[136:137], v[120:121], v[72:73] op_sel_hi:[0,1,1] neg_lo:[1,0,0] neg_hi:[1,0,0]
    v_exp_f32 v130, v130
    v_exp_f32 v131, v131
    v_pk_fma_f32 v[74:75], v[136:137], v[122:123], v[74:75] op_sel_hi:[0,1,1] neg_lo:[1,0,0] neg_hi:[1,0,0]
    v_exp_f32 v132, v132
    v_exp_f32 v133, v133
    v_pk_fma_f32 v[76:77], v[136:137], v[124:125], v[76:77] op_sel_hi:[0,1,1] neg_lo:[1,0,0] neg_hi:[1,0,0]
    v_exp_f32 v134, v134
    v_exp_f32 v135, v135
    v_pk_fma_f32 v[78:79], v[136:137], v[126:127], v[78:79] op_sel_hi:[0,1,1] neg_lo:[1,0,0] neg_hi:[1,0,0]
    v_pk_add_f32 v[128:129], v[128:129], 1.0 op_sel_hi:[1,0]
    v_pk_add_f32 v[130:131], v[130:131], 1.0 op_sel_hi:[1,0]
    v_pk_add_f32 v[132:133], v[132:133], 1.0 op_sel_hi:[1,0]
    v_pk_add_f32 v[134:135], v[134:135], 1.0 op_sel_hi:[1,0]
    v_rcp_f32 v128, v128
    v_rcp_f32 v129, v129
    v_pk_mul_f32 v[64:65], v[64:65], v[72:73]
    v_rcp_f32 v130, v130
    v_rcp_f32 v131, v131
    v_pk_mul_f32 v[66:67], v[66:67], v[74:75]
    v_rcp_f32 v132, v132
    v_rcp_f32 v133, v133
    v_pk_mul_f32 v[68:69], v[68:69], v[76:77]
    v_rcp_f32 v134, v134
    v_rcp_f32 v135, v135
    v_pk_mul_f32 v[70:71], v[70:71], v[78:79]
    v_pk_mul_f32 v[64:65], v[64:65], v[128:129]
    v_pk_mul_f32 v[66:67], v[66:67], v[130:131]
    v_pk_mul_f32 v[68:69], v[68:69], v[132:133]
    v_pk_mul_f32 v[70:71], v[70:71], v[134:135]
    v_cvt_pk_bf16_f32 v72, v64, v65
    v_cvt_pk_bf16_f32 v73, v66, v67
    v_cvt_pk_bf16_f32 v74, v68, v69
    v_cvt_pk_bf16_f32 v75, v70, v71
    s_add_u32 s8, s70, 57344
    buffer_store_dwordx4 v[72:75], v12, s[52:55], s8 offen offset:1024 sc1
    s_waitcnt vmcnt(0)
    s_add_u32 s8, s71, 8192
    v_mov_b32 v14, s42
    buffer_store_dword v14, off, s[52:55], s8 sc1
    s_lshl_b32 s8, s3, 2
    s_add_u32 s8, s8, 161856
    v_mov_b32 v3, s8
    ds_write_b32 v3, v14
    s_setprio 0
    s_cmp_ge_u32 s3, 4
    s_cbranch_scc1 Lg2_20
    s_setprio 0
    s_cmp_lt_u32 s3, 4
    s_cbranch_scc1 Lup0_24
    s_branch Lnoconv_22
Lup0_24:
    s_mov_b32 s13, s3
Lconv2_23:
    s_bfe_u32 s8, s3, 0x10001
    s_and_b32 s9, s3, 1
    s_lshl_b32 s11, s9, 9
    s_add_u32 s11, s11, 1024
    s_cmp_ge_u32 s13, 4
    s_cselect_b32 s11, s11, 0
    s_cselect_b32 s12, 7, 8
    s_cselect_b64 s[88:89], -1, 0
    v_and_b32 v120, 15, v1
    v_lshrrev_b32 v121, 4, v1
    v_lshlrev_b32 v122, s12, v121
    v_add_u32 v122, s11, v122
    v_lshl_add_u32 v2, v120, 3, v122
    v_lshlrev_b32 v2, 1, v2
    s_mul_i32 s10, s8, 5120
    s_add_u32 s10, s10, 147456
    v_add_u32 v2, s10, v2
    v_or_b32 v123, 8, v120
    v_cmp_gt_u32 vcc, 8, v120
    v_mov_b32 v125, s9
    s_nop 0
    v_cndmask_b32 v124, 0, 1, vcc
    v_cndmask_b32 v123, v120, v123, s[88:89]
    v_cndmask_b32 v124, v125, v124, s[88:89]
    v_sub_u32 v123, 15, v123
    v_lshrrev_b32 v125, 7, v122
    v_add_u32 v123, v123, v125
    v_mul_u32_u24 v124, 6144, v124
    s_mul_i32 s10, s8, 12288
    s_add_u32 s10, s10, 114688
    v_add_u32 v124, s10, v124
    v_add_u32 v125, 0, v123
    v_and_b32 v126, 15, v125
    v_lshlrev_b32 v125, 8, v125
    v_lshl_or_b32 v125, v126, 4, v125
    v_add_u32 v3, v124, v125
    v_add_u32 v125, 1, v123
    v_and_b32 v126, 15, v125
    v_lshlrev_b32 v125, 8, v125
    v_lshl_or_b32 v125, v126, 4, v125
    v_add_u32 v4, v124, v125
    s_mov_b64 vcc, s[88:89]
    ds_read_b128 v[16:19], v2 offset:0
    ds_read_b128 v[20:23], v2 offset:16
    v_xor_b32 v10, 0, v3
    ds_read_b128 v[88:91], v10
    ds_read_b128 v[24:27], v2 offset:32
    v_xor_b32 v11, 16, v3
    ds_read_b128 v[92:95], v11
    ds_read_b128 v[28:31], v2 offset:48
    v_xor_b32 v10, 32, v3
    ds_read_b128 v[96:99], v10
    ds_read_b128 v[32:35], v2 offset:64
    s_waitcnt lgkmcnt(6)
    v_alignbit_b32 v54, v18, v17, 16
    v_alignbit_b32 v55, v19, v18, 16
    v_alignbit_b32 v56, v20, v19, 16
    v_alignbit_b32 v57, v21, v20, 16
    v_alignbit_b32 v58, v22, v21, 16
    v_alignbit_b32 v59, v23, v22, 16
    s_waitcnt lgkmcnt(4)
    v_mfma_f32_16x16x32_bf16 v[104:107], v[54:57], v[88:91], 0
    v_xor_b32 v11, 48, v3
    ds_read_b128 v[36:39], v2 offset:80
    v_mfma_f32_16x16x32_bf16 v[112:115], v[56:59], v[88:91], 0
    v_alignbit_b32 v60, v24, v23, 16
    v_alignbit_b32 v61, v25, v24, 16
    v_mfma_f32_16x16x32_bf16 v[108:111], v[18:21], v[88:91], 0
    v_alignbit_b32 v62, v26, v25, 16
    v_alignbit_b32 v63, v27, v26, 16
    v_mfma_f32_16x16x32_bf16 v[116:119], v[20:23], v[88:91], 0
    ds_read_b128 v[100:103], v11
    s_waitcnt lgkmcnt(4)
    v_mfma_f32_16x16x32_bf16 v[104:107], v[58:61], v[92:95], v[104:107]
    v_xor_b32 v10, 64, v3
    ds_read_b128 v[40:43], v2 offset:96
    v_mfma_f32_16x16x32_bf16 v[112:115], v[60:63], v[92:95], v[112:115]
    v_alignbit_b32 v64, v28, v27, 16
    v_alignbit_b32 v65, v29, v28, 16
    v_mfma_f32_16x16x32_bf16 v[108:111], v[22:25], v[92:95], v[108:111]
    v_alignbit_b32 v66, v30, v29, 16
    v_alignbit_b32 v67, v31, v30, 16
    v_mfma_f32_16x16x32_bf16 v[116:119], v[24:27], v[92:95], v[116:119]
    ds_read_b128 v[88:91], v10
    s_waitcnt lgkmcnt(4)
    v_mfma_f32_16x16x32_bf16 v[104:107], v[62:65], v[96:99], v[104:107]
    v_xor_b32 v11, 80, v3
    ds_read_b128 v[44:47], v2 offset:112
    v_mfma_f32_16x16x32_bf16 v[112:115], v[64:67], v[96:99], v[112:115]
    v_alignbit_b32 v68, v32, v31, 16
    v_alignbit_b32 v69, v33, v32, 16
    v_mfma_f32_16x16x32_bf16 v[108:111], v[26:29], v[96:99], v[108:111]
    v_alignbit_b32 v70, v34, v33, 16
    v_alignbit_b32 v71, v35, v34, 16
    v_mfma_f32_16x16x32_bf16 v[116:119], v[28:31], v[96:99], v[116:119]
    ds_read_b128 v[92:95], v11
    s_waitcnt lgkmcnt(4)
    v_mfma_f32_16x16x32_bf16 v[104:107], v[66:69], v[100:103], v[104:107]
    v_xor_b32 v10, 96, v3
    ds_read_b128 v[48:51], v2 offset:128
    v_mfma_f32_16x16x32_bf16 v[112:115], v[68:71], v[100:103], v[112:115]
    v_alignbit_b32 v72, v36, v35, 16
    v_alignbit_b32 v73, v37, v36, 16
    v_mfma_f32_16x16x32_bf16 v[108:111], v[30:33], v[100:103], v[108:111]
    v_alignbit_b32 v74, v38, v37, 16
    v_alignbit_b32 v75, v39, v38, 16
    v_mfma_f32_16x16x32_bf16 v[116:119], v[32:35], v[100:103], v[116:119]
    ds_read_b128 v[96:99], v10
    s_waitcnt lgkmcnt(4)
    v_mfma_f32_16x16x32_bf16 v[104:107], v[70:73], v[88:91], v[104:107]
    v_xor_b32 v11, 112, v3
    ds_read_b128 v[16:19], v2 offset:128
    ds_read_b128 v[20:23], v2 offset:144
    v_mfma_f32_16x16x32_bf16 v[112:115], v[72:75], v[88:91], v[112:115]
    v_alignbit_b32 v76, v40, v39, 16
    v_alignbit_b32 v77, v41, v40, 16
    v_mfma_f32_16x16x32_bf16 v[108:111], v[34:37], v[88:91], v[108:111]
    v_alignbit_b32 v78, v42, v41, 16
    v_alignbit_b32 v79, v43, v42, 16
    v_mfma_f32_16x16x32_bf16 v[116:119], v[36:39], v[88:91], v[116:119]
    ds_read_b128 v[100:103], v11
    s_waitcnt lgkmcnt(5)
    v_mfma_f32_16x16x32_bf16 v[104:107], v[74:77], v[92:95], v[104:107]
    v_xor_b32 v10, 128, v3
    ds_read_b128 v[24:27], v2 offset:160
    v_mfma_f32_16x16x32_bf16 v[112:115], v[76:79], v[92:95], v[112:115]
    v_alignbit_b32 v80, v44, v43, 16
    v_alignbit_b32 v81, v45, v44, 16
    v_mfma_f32_16x16x32_bf16 v[108:111], v[38:41], v[92:95], v[108:111]
    v_alignbit_b32 v82, v46, v45, 16
    v_alignbit_b32 v83, v47, v46, 16
    v_mfma_f32_16x16x32_bf16 v[116:119], v[40:43], v[92:95], v[116:119]
    ds_read_b128 v[88:91], v10
    s_waitcnt lgkmcnt(5)
    v_mfma_f32_16x16x32_bf16 v[104:107], v[78:81], v[96:99], v[104:107]
    v_xor_b32 v11, 144, v3
    ds_read_b128 v[28:31], v2 offset:176
    v_mfma_f32_16x16x32_bf16 v[112:115], v[80:83], v[96:99], v[112:115]
    v_alignbit_b32 v84, v48, v47, 16
    v_alignbit_b32 v85, v49, v48, 16
    v_mfma_f32_16x16x32_bf16 v[108:111], v[42:45], v[96:99], v[108:111]
    v_alignbit_b32 v86, v50, v49, 16
    v_alignbit_b32 v87, v51, v50, 16
    v_mfma_f32_16x16x32_bf16 v[116:119], v[44:47], v[96:99], v[116:119]
    ds_read_b128 v[92:95], v11
    s_waitcnt lgkmcnt(4)
    v_mfma_f32_16x16x32_bf16 v[104:107], v[82:85], v[100:103], v[104:107]
    v_xor_b32 v10, 160, v3
    ds_read_b128 v[32:35], v2 offset:192
    v_mfma_f32_16x16x32_bf16 v[112:115], v[84:87], v[100:103], v[112:115]
    v_alignbit_b32 v54, v18, v17, 16
    v_alignbit_b32 v55, v19, v18, 16
    v_mfma_f32_16x16x32_bf16 v[108:111], v[46:49], v[100:103], v[108:111]
    v_alignbit_b32 v56, v20, v19, 16
    v_alignbit_b32 v57, v21, v20, 16
    v_mfma_f32_16x16x32_bf16 v[116:119], v[48:51], v[100:103], v[116:119]
    v_alignbit_b32 v58, v22, v21, 16
    v_alignbit_b32 v59, v23, v22, 16
    ds_read_b128 v[96:99], v10
    s_waitcnt lgkmcnt(4)
    v_mfma_f32_16x16x32_bf16 v[104:107], v[54:57], v[88:91], v[104:107]
    v_xor_b32 v11, 176, v3
    ds_read_b128 v[36:39], v2 offset:208
    v_mfma_f32_16x16x32_bf16 v[112:115], v[56:59], v[88:91], v[112:115]
    v_alignbit_b32 v60, v24, v23, 16
    v_alignbit_b32 v61, v25, v24, 16
    v_mfma_f32_16x16x32_bf16 v[108:111], v[18:21], v[88:91], v[108:111]
    v_alignbit_b32 v62, v26, v25, 16
    v_alignbit_b32 v63, v27, v26, 16
    v_mfma_f32_16x16x32_bf16 v[116:119], v[20:23], v[88:91], v[116:119]
    ds_read_b128 v[100:103], v11
    s_waitcnt lgkmcnt(4)
    v_mfma_f32_16x16x32_bf16 v[104:107], v[58:61], v[92:95], v[104:107]
    v_xor_b32 v10, 192, v3
    ds_read_b128 v[40:43], v2 offset:224
    v_mfma_f32_16x16x32_bf16 v[112:115], v[60:63], v[92:95], v[112:115]
    v_alignbit_b32 v64, v28, v27, 16
    v_alignbit_b32 v65, v29, v28, 16
    v_mfma_f32_16x16x32_bf16 v[108:111], v[22:25], v[92:95], v[108:111]
    v_alignbit_b32 v66, v30, v29, 16
    v_alignbit_b32 v67, v31, v30, 16
    v_mfma_f32_16x16x32_bf16 v[116:119], v[24:27], v[92:95], v[116:119]
    ds_read_b128 v[88:91], v10
    s_waitcnt lgkmcnt(4)
    v_mfma_f32_16x16x32_bf16 v[104:107], v[62:65], v[96:99], v[104:107]
    v_xor_b32 v11, 208, v3
    ds_read_b128 v[44:47], v2 offset:240
    v_mfma_f32_16x16x32_bf16 v[112:115], v[64:67], v[96:99], v[112:115]
    v_alignbit_b32 v68, v32, v31, 16
    v_alignbit_b32 v69, v33, v32, 16
    v_mfma_f32_16x16x32_bf16 v[108:111], v[26:29], v[96:99], v[108:111]
    v_alignbit_b32 v70, v34, v33, 16
    v_alignbit_b32 v71, v35, v34, 16
    v_mfma_f32_16x16x32_bf16 v[116:119], v[28:31], v[96:99], v[116:119]
    ds_read_b128 v[92:95], v11
    s_waitcnt lgkmcnt(4)
    v_mfma_f32_16x16x32_bf16 v[104:107], v[66:69], v[100:103], v[104:107]
    v_xor_b32 v10, 224, v3
    ds_read_b128 v[48:51], v2 offset:256
    v_mfma_f32_16x16x32_bf16 v[112:115], v[68:71], v[100:103], v[112:115]
    v_alignbit_b32 v72, v36, v35, 16
    v_alignbit_b32 v73, v37, v36, 16
    v_mfma_f32_16x16x32_bf16 v[108:111], v[30:33], v[100:103], v[108:111]
    v_alignbit_b32 v74, v38, v37, 16
    v_alignbit_b32 v75, v39, v38, 16
    v_mfma_f32_16x16x32_bf16 v[116:119], v[32:35], v[100:103], v[116:119]
    ds_read_b128 v[96:99], v10
    s_waitcnt lgkmcnt(4)
    v_mfma_f32_16x16x32_bf16 v[104:107], v[70:73], v[88:91], v[104:107]
    v_xor_b32 v11, 240, v3
    ds_read_b128 v[16:19], v2 offset:256
    ds_read_b128 v[20:23], v2 offset:272
    v_mfma_f32_16x16x32_bf16 v[112:115], v[72:75], v[88:91], v[112:115]
    v_alignbit_b32 v76, v40, v39, 16
    v_alignbit_b32 v77, v41, v40, 16
    v_mfma_f32_16x16x32_bf16 v[108:111], v[34:37], v[88:91], v[108:111]
    v_alignbit_b32 v78, v42, v41, 16
    v_alignbit_b32 v79, v43, v42, 16
    v_mfma_f32_16x16x32_bf16 v[116:119], v[36:39], v[88:91], v[116:119]
    ds_read_b128 v[100:103], v11
    s_waitcnt lgkmcnt(5)
    v_mfma_f32_16x16x32_bf16 v[104:107], v[74:77], v[92:95], v[104:107]
    v_xor_b32 v10, 0, v4
    ds_read_b128 v[24:27], v2 offset:288
    v_mfma_f32_16x16x32_bf16 v[112:115], v[76:79], v[92:95], v[112:115]
    v_alignbit_b32 v80, v44, v43, 16
    v_alignbit_b32 v81, v45, v44, 16
    v_mfma_f32_16x16x32_bf16 v[108:111], v[38:41], v[92:95], v[108:111]
    v_alignbit_b32 v82, v46, v45, 16
    v_alignbit_b32 v83, v47, v46, 16
    v_mfma_f32_16x16x32_bf16 v[116:119], v[40:43], v[92:95], v[116:119]
    ds_read_b128 v[88:91], v10
    s_waitcnt lgkmcnt(5)
    v_mfma_f32_16x16x32_bf16 v[104:107], v[78:81], v[96:99], v[104:107]
    v_xor_b32 v11, 16, v4
    ds_read_b128 v[28:31], v2 offset:304
    v_mfma_f32_16x16x32_bf16 v[112:115], v[80:83], v[96:99], v[112:115]
    v_alignbit_b32 v84, v48, v47, 16
    v_alignbit_b32 v85, v49, v48, 16
    v_mfma_f32_16x16x32_bf16 v[108:111], v[42:45], v[96:99], v[108:111]
    v_alignbit_b32 v86, v50, v49, 16
    v_alignbit_b32 v87, v51, v50, 16
    v_mfma_f32_16x16x32_bf16 v[116:119], v[44:47], v[96:99], v[116:119]
    ds_read_b128 v[92:95], v11
    s_waitcnt lgkmcnt(4)
    v_mfma_f32_16x16x32_bf16 v[104:107], v[82:85], v[100:103], v[104:107]
    v_xor_b32 v10, 32, v4
    ds_read_b128 v[32:35], v2 offset:320
    v_mfma_f32_16x16x32_bf16 v[112:115], v[84:87], v[100:103], v[112:115]
    v_alignbit_b32 v54, v18, v17, 16
    v_alignbit_b32 v55, v19, v18, 16
    v_mfma_f32_16x16x32_bf16 v[108:111], v[46:49], v[100:103], v[108:111]
    v_alignbit_b32 v56, v20, v19, 16
    v_alignbit_b32 v57, v21, v20, 16
    v_mfma_f32_16x16x32_bf16 v[116:119], v[48:51], v[100:103], v[116:119]
    v_alignbit_b32 v58, v22, v21, 16
    v_alignbit_b32 v59, v23, v22, 16
    ds_read_b128 v[96:99], v10
    s_cbranch_vccnz Lconvout_25
    s_waitcnt lgkmcnt(4)
    v_mfma_f32_16x16x32_bf16 v[104:107], v[54:57], v[88:91], v[104:107]
    v_xor_b32 v11, 48, v4
    ds_read_b128 v[36:39], v2 offset:336
    v_mfma_f32_16x16x32_bf16 v[112:115], v[56:59], v[88:91], v[112:115]
    v_alignbit_b32 v60, v24, v23, 16
    v_alignbit_b32 v61, v25, v24, 16
    v_mfma_f32_16x16x32_bf16 v[108:111], v[18:21], v[88:91], v[108:111]
    v_alignbit_b32 v62, v26, v25, 16
    v_alignbit_b32 v63, v27, v26, 16
    v_mfma_f32_16x16x32_bf16 v[116:119], v[20:23], v[88:91], v[116:119]
    ds_read_b128 v[100:103], v11
    s_waitcnt lgkmcnt(4)
    v_mfma_f32_16x16x32_bf16 v[104:107], v[58:61], v[92:95], v[104:107]
    v_xor_b32 v10, 64, v4
    ds_read_b128 v[40:43], v2 offset:352
    v_mfma_f32_16x16x32_bf16 v[112:115], v[60:63], v[92:95], v[112:115]
    v_alignbit_b32 v64, v28, v27, 16
    v_alignbit_b32 v65, v29, v28, 16
    v_mfma_f32_16x16x32_bf16 v[108:111], v[22:25], v[92:95], v[108:111]
    v_alignbit_b32 v66, v30, v29, 16
    v_alignbit_b32 v67, v31, v30, 16
    v_mfma_f32_16x16x32_bf16 v[116:119], v[24:27], v[92:95], v[116:119]
    ds_read_b128 v[88:91], v10
    s_waitcnt lgkmcnt(4)
    v_mfma_f32_16x16x32_bf16 v[104:107], v[62:65], v[96:99], v[104:107]
    v_xor_b32 v11, 80, v4
    ds_read_b128 v[44:47], v2 offset:368
    v_mfma_f32_16x16x32_bf16 v[112:115], v[64:67], v[96:99], v[112:115]
    v_alignbit_b32 v68, v32, v31, 16
    v_alignbit_b32 v69, v33, v32, 16
    v_mfma_f32_16x16x32_bf16 v[108:111], v[26:29], v[96:99], v[108:111]
    v_alignbit_b32 v70, v34, v33, 16
    v_alignbit_b32 v71, v35, v34, 16
    v_mfma_f32_16x16x32_bf16 v[116:119], v[28:31], v[96:99], v[116:119]
    ds_read_b128 v[92:95], v11
    s_waitcnt lgkmcnt(4)
    v_mfma_f32_16x16x32_bf16 v[104:107], v[66:69], v[100:103], v[104:107]
    v_xor_b32 v10, 96, v4
    ds_read_b128 v[48:51], v2 offset:384
    v_mfma_f32_16x16x32_bf16 v[112:115], v[68:71], v[100:103], v[112:115]
    v_alignbit_b32 v72, v36, v35, 16
    v_alignbit_b32 v73, v37, v36, 16
    v_mfma_f32_16x16x32_bf16 v[108:111], v[30:33], v[100:103], v[108:111]
    v_alignbit_b32 v74, v38, v37, 16
    v_alignbit_b32 v75, v39, v38, 16
    v_mfma_f32_16x16x32_bf16 v[116:119], v[32:35], v[100:103], v[116:119]
    ds_read_b128 v[96:99], v10
    s_waitcnt lgkmcnt(4)
    v_mfma_f32_16x16x32_bf16 v[104:107], v[70:73], v[88:91], v[104:107]
    v_xor_b32 v11, 112, v4
    ds_read_b128 v[16:19], v2 offset:384
    ds_read_b128 v[20:23], v2 offset:400
    v_mfma_f32_16x16x32_bf16 v[112:115], v[72:75], v[88:91], v[112:115]
    v_alignbit_b32 v76, v40, v39, 16
    v_alignbit_b32 v77, v41, v40, 16
    v_mfma_f32_16x16x32_bf16 v[108:111], v[34:37], v[88:91], v[108:111]
    v_alignbit_b32 v78, v42, v41, 16
    v_alignbit_b32 v79, v43, v42, 16
    v_mfma_f32_16x16x32_bf16 v[116:119], v[36:39], v[88:91], v[116:119]
    ds_read_b128 v[100:103], v11
    s_waitcnt lgkmcnt(5)
    v_mfma_f32_16x16x32_bf16 v[104:107], v[74:77], v[92:95], v[104:107]
    v_xor_b32 v10, 128, v4
    ds_read_b128 v[24:27], v2 offset:416
    v_mfma_f32_16x16x32_bf16 v[112:115], v[76:79], v[92:95], v[112:115]
    v_alignbit_b32 v80, v44, v43, 16
    v_alignbit_b32 v81, v45, v44, 16
    v_mfma_f32_16x16x32_bf16 v[108:111], v[38:41], v[92:95], v[108:111]
    v_alignbit_b32 v82, v46, v45, 16
    v_alignbit_b32 v83, v47, v46, 16
    v_mfma_f32_16x16x32_bf16 v[116:119], v[40:43], v[92:95], v[116:119]
    ds_read_b128 v[88:91], v10
    s_waitcnt lgkmcnt(5)
    v_mfma_f32_16x16x32_bf16 v[104:107], v[78:81], v[96:99], v[104:107]
    v_xor_b32 v11, 144, v4
    ds_read_b128 v[28:31], v2 offset:432
    v_mfma_f32_16x16x32_bf16 v[112:115], v[80:83], v[96:99], v[112:115]
    v_alignbit_b32 v84, v48, v47, 16
    v_alignbit_b32 v85, v49, v48, 16
    v_mfma_f32_16x16x32_bf16 v[108:111], v[42:45], v[96:99], v[108:111]
    v_alignbit_b32 v86, v50, v49, 16
    v_alignbit_b32 v87, v51, v50, 16
    v_mfma_f32_16x16x32_bf16 v[116:119], v[44:47], v[96:99], v[116:119]
    ds_read_b128 v[92:95], v11
    s_waitcnt lgkmcnt(4)
    v_mfma_f32_16x16x32_bf16 v[104:107], v[82:85], v[100:103], v[104:107]
    v_xor_b32 v10, 160, v4
    ds_read_b128 v[32:35], v2 offset:448
    v_mfma_f32_16x16x32_bf16 v[112:115], v[84:87], v[100:103], v[112:115]
    v_alignbit_b32 v54, v18, v17, 16
    v_alignbit_b32 v55, v19, v18, 16
    v_mfma_f32_16x16x32_bf16 v[108:111], v[46:49], v[100:103], v[108:111]
    v_alignbit_b32 v56, v20, v19, 16
    v_alignbit_b32 v57, v21, v20, 16
    v_mfma_f32_16x16x32_bf16 v[116:119], v[48:51], v[100:103], v[116:119]
    v_alignbit_b32 v58, v22, v21, 16
    v_alignbit_b32 v59, v23, v22, 16
    ds_read_b128 v[96:99], v10
    s_waitcnt lgkmcnt(4)
    v_mfma_f32_16x16x32_bf16 v[104:107], v[54:57], v[88:91], v[104:107]
    v_xor_b32 v11, 176, v4
    ds_read_b128 v[36:39], v2 offset:464
    v_mfma_f32_16x16x32_bf16 v[112:115], v[56:59], v[88:91], v[112:115]
    v_alignbit_b32 v60, v24, v23, 16
    v_alignbit_b32 v61, v25, v24, 16
    v_mfma_f32_16x16x32_bf16 v[108:111], v[18:21], v[88:91], v[108:111]
    v_alignbit_b32 v62, v26, v25, 16
    v_alignbit_b32 v63, v27, v26, 16
    v_mfma_f32_16x16x32_bf16 v[116:119], v[20:23], v[88:91], v[116:119]
    ds_read_b128 v[100:103], v11
    s_waitcnt lgkmcnt(4)
    v_mfma_f32_16x16x32_bf16 v[104:107], v[58:61], v[92:95], v[104:107]
    v_xor_b32 v10, 192, v4
    ds_read_b128 v[40:43], v2 offset:480
    v_mfma_f32_16x16x32_bf16 v[112:115], v[60:63], v[92:95], v[112:115]
    v_alignbit_b32 v64, v28, v27, 16
    v_alignbit_b32 v65, v29, v28, 16
    v_mfma_f32_16x16x32_bf16 v[108:111], v[22:25], v[92:95], v[108:111]
    v_alignbit_b32 v66, v30, v29, 16
    v_alignbit_b32 v67, v31, v30, 16
    v_mfma_f32_16x16x32_bf16 v[116:119], v[24:27], v[92:95], v[116:119]
    ds_read_b128 v[88:91], v10
    s_waitcnt lgkmcnt(4)
    v_mfma_f32_16x16x32_bf16 v[104:107], v[62:65], v[96:99], v[104:107]
    v_xor_b32 v11, 208, v4
    ds_read_b128 v[44:47], v2 offset:496
    v_mfma_f32_16x16x32_bf16 v[112:115], v[64:67], v[96:99], v[112:115]
    v_alignbit_b32 v68, v32, v31, 16
    v_alignbit_b32 v69, v33, v32, 16
    v_mfma_f32_16x16x32_bf16 v[108:111], v[26:29], v[96:99], v[108:111]
    v_alignbit_b32 v70, v34, v33, 16
    v_alignbit_b32 v71, v35, v34, 16
    v_mfma_f32_16x16x32_bf16 v[116:119], v[28:31], v[96:99], v[116:119]
    ds_read_b128 v[92:95], v11
    s_waitcnt lgkmcnt(4)
    v_mfma_f32_16x16x32_bf16 v[104:107], v[66:69], v[100:103], v[104:107]
    v_xor_b32 v10, 224, v4
    ds_read_b128 v[48:51], v2 offset:512
    v_mfma_f32_16x16x32_bf16 v[112:115], v[68:71], v[100:103], v[112:115]
    v_alignbit_b32 v72, v36, v35, 16
    v_alignbit_b32 v73, v37, v36, 16
    v_mfma_f32_16x16x32_bf16 v[108:111], v[30:33], v[100:103], v[108:111]
    v_alignbit_b32 v74, v38, v37, 16
    v_alignbit_b32 v75, v39, v38, 16
    v_mfma_f32_16x16x32_bf16 v[116:119], v[32:35], v[100:103], v[116:119]
    ds_read_b128 v[96:99], v10
    s_waitcnt lgkmcnt(4)
    v_mfma_f32_16x16x32_bf16 v[104:107], v[70:73], v[88:91], v[104:107]
    v_xor_b32 v11, 240, v4
    v_mfma_f32_16x16x32_bf16 v[112:115], v[72:75], v[88:91], v[112:115]
    v_alignbit_b32 v76, v40, v39, 16
    v_alignbit_b32 v77, v41, v40, 16
    v_mfma_f32_16x16x32_bf16 v[108:111], v[34:37], v[88:91], v[108:111]
    v_alignbit_b32 v78, v42, v41, 16
    v_alignbit_b32 v79, v43, v42, 16
    v_mfma_f32_16x16x32_bf16 v[116:119], v[36:39], v[88:91], v[116:119]
    ds_read_b128 v[100:103], v11
    s_waitcnt lgkmcnt(3)
    v_mfma_f32_16x16x32_bf16 v[104:107], v[74:77], v[92:95], v[104:107]
    v_mfma_f32_16x16x32_bf16 v[112:115], v[76:79], v[92:95], v[112:115]
    v_alignbit_b32 v80, v44, v43, 16
    v_alignbit_b32 v81, v45, v44, 16
    v_mfma_f32_16x16x32_bf16 v[108:111], v[38:41], v[92:95], v[108:111]
    v_alignbit_b32 v82, v46, v45, 16
    v_alignbit_b32 v83, v47, v46, 16
    v_mfma_f32_16x16x32_bf16 v[116:119], v[40:43], v[92:95], v[116:119]
    s_waitcnt lgkmcnt(1)
    v_mfma_f32_16x16x32_bf16 v[104:107], v[78:81], v[96:99], v[104:107]
    v_mfma_f32_16x16x32_bf16 v[112:115], v[80:83], v[96:99], v[112:115]
    v_alignbit_b32 v84, v48, v47, 16
    v_alignbit_b32 v85, v49, v48, 16
    v_mfma_f32_16x16x32_bf16 v[108:111], v[42:45], v[96:99], v[108:111]
    v_alignbit_b32 v86, v50, v49, 16
    v_alignbit_b32 v87, v51, v50, 16
    v_mfma_f32_16x16x32_bf16 v[116:119], v[44:47], v[96:99], v[116:119]
    s_waitcnt lgkmcnt(0)
    v_mfma_f32_16x16x32_bf16 v[104:107], v[82:85], v[100:103], v[104:107]
    v_mfma_f32_16x16x32_bf16 v[112:115], v[84:87], v[100:103], v[112:115]
    v_mfma_f32_16x16x32_bf16 v[108:111], v[46:49], v[100:103], v[108:111]
    v_mfma_f32_16x16x32_bf16 v[116:119], v[48:51], v[100:103], v[116:119]
Lconvout_25:
    s_waitcnt lgkmcnt(0)
    v_and_b32 v3, 3, v1
    v_lshlrev_b32 v3, 2, v3
    v_add_u32 v3, 161872, v3
    s_mov_b32 s9, 0
Lw9_26:
    ds_read_b32 v4, v3
    s_waitcnt lgkmcnt(0)
    v_cmp_ne_u32 vcc, s42, v4
    s_cbranch_vccz Lok9_27
    s_add_u32 s9, s9, 1
    s_cmp_lt_u32 s9, 1000000
    s_cbranch_scc1 Lw9_26
Lok9_27:
    s_lshl_b32 s8, s13, 11
    s_add_u32 s8, s8, 81920
    v_add_u32 v2, s8, v12
    s_nop 5
    ds_write_b128 v2, v[104:107] offset:0
    ds_write_b128 v2, v[108:111] offset:1024
    ds_write_b128 v2, v[112:115] offset:16384
    ds_write_b128 v2, v[116:119] offset:17408
    s_lshl_b32 s8, s13, 2
    s_add_u32 s8, s8, 161792
    v_mov_b32 v2, s8
    v_mov_b32 v3, s42
    ds_write_b32 v2, v3
    s_cmp_ge_u32 s13, 4
    s_cbranch_scc1 Lnoconv_22
    s_add_u32 s13, s13, 4
    s_and_b32 s8, s3, 2
    s_lshl_b32 s8, s8, 2
    s_add_u32 s8, s8, 161856
    v_and_b32 v3, 1, v1
    v_lshl_add_u32 v3, v3, 2, s8
    s_lshl_b32 s8, s13, 2
    s_add_u32 s8, s8, 161856
    v_writelane_b32 v3, s8, 2
    s_mov_b32 s9, 0
Luf_28:
    ds_read_b32 v4, v3
    s_waitcnt lgkmcnt(0)
    v_cmp_ne_u32 vcc, s42, v4
    s_cbranch_vccz Lufok_29
    s_add_u32 s9, s9, 1
    s_cmp_lt_u32 s9, 1000000
    s_cbranch_scc1 Luf_28
Lufok_29:
    s_branch Lconv2_23
Lnoconv_22:
    v_and_b32 v2, 7, v1
    v_lshlrev_b32 v2, 2, v2
    v_add_u32 v2, 161792, v2
    s_mov_b32 s12, 0x33
    s_lshl_b32 s13, s5, 1
    s_lshl_b32 s12, s12, s13
    s_mov_b32 s9, 0
Llf_30:
    ds_read_b32 v3, v2
    s_waitcnt lgkmcnt(0)
    v_cmp_ne_u32 vcc, s42, v3
    s_and_b32 s8, vcc_lo, s12
    s_cbranch_scc0 Llfok_31
    s_add_u32 s9, s9, 1
    s_cmp_lt_u32 s9, 1000000
    s_cbranch_scc1 Llf_30
Llfok_31:
    s_lshl_b32 s8, s5, 12
    s_lshl_b32 s11, s4, 9
    s_add_u32 s8, s8, s11
    s_add_u32 s8, s8, 81920
    v_add_u32 v2, s8, v13
    v_subrev_u32 v3, 128, v2
    v_lshrrev_b32 v16, 2, v1
    v_and_b32 v17, 3, v1
    v_sub_u32 v18, 15, v16
    s_mul_i32 s12, s5, 12288
    s_add_u32 s12, s12, 120832
    ds_read_b32 v24, v2 offset:0
    ds_read_b32 v25, v2 offset:1024
    ds_read_b32 v28, v2 offset:16384
    ds_read_b32 v29, v2 offset:17408
    ds_read_b32 v26, v2 offset:2048
    ds_read_b32 v27, v2 offset:3072
    ds_read_b32 v30, v2 offset:18432
    ds_read_b32 v31, v2 offset:19456
    s_lshl_b32 s11, s4, 3
    s_sub_u32 s11, 15, s11
    v_sub_u32 v19, s11, v17
    v_xor_b32 v19, v19, v18
    v_lshlrev_b32 v20, 8, v18
    v_lshl_add_u32 v19, v19, 4, v20
    v_add_u32 v19, s12, v19
    ds_read_b128 v[48:51], v19
    ds_read_b32 v52, v2 offset:256
    ds_read_b32 v53, v2 offset:1280
    ds_read_b32 v56, v2 offset:16640
    ds_read_b32 v57, v2 offset:17664
    ds_read_b32 v54, v2 offset:2304
    ds_read_b32 v55, v2 offset:3328
    ds_read_b32 v58, v2 offset:18688
    ds_read_b32 v59, v2 offset:19712
    s_lshl_b32 s11, s4, 3
    s_sub_u32 s11, 11, s11
    v_sub_u32 v19, s11, v17
    v_xor_b32 v19, v19, v18
    v_lshlrev_b32 v20, 8, v18
    v_lshl_add_u32 v19, v19, 4, v20
    v_add_u32 v19, s12, v19
    ds_read_b128 v[76:79], v19
    s_mov_b32 exec_lo, 0
    ds_read_b32 v32, v2 offset:8192
    ds_read_b32 v33, v2 offset:9216
    ds_read_b32 v36, v2 offset:24576
    ds_read_b32 v37, v2 offset:25600
    ds_read_b32 v34, v3 offset:8192
    ds_read_b32 v35, v3 offset:9216
    ds_read_b32 v38, v3 offset:24576
    ds_read_b32 v39, v3 offset:25600
    ds_read_b32 v40, v2 offset:10240
    ds_read_b32 v41, v2 offset:11264
    ds_read_b32 v44, v2 offset:26624
    ds_read_b32 v45, v2 offset:27648
    ds_read_b32 v42, v3 offset:10240
    ds_read_b32 v43, v3 offset:11264
    ds_read_b32 v46, v3 offset:26624
    ds_read_b32 v47, v3 offset:27648
    ds_read_b32 v60, v2 offset:8448
    ds_read_b32 v61, v2 offset:9472
    ds_read_b32 v64, v2 offset:24832
    ds_read_b32 v65, v2 offset:25856
    ds_read_b32 v62, v3 offset:8448
    ds_read_b32 v63, v3 offset:9472
    ds_read_b32 v66, v3 offset:24832
    ds_read_b32 v67, v3 offset:25856
    ds_read_b32 v68, v2 offset:10496
    ds_read_b32 v69, v2 offset:11520
    ds_read_b32 v72, v2 offset:26880
    ds_read_b32 v73, v2 offset:27904
    ds_read_b32 v70, v3 offset:10496
    ds_read_b32 v71, v3 offset:11520
    ds_read_b32 v74, v3 offset:26880
    ds_read_b32 v75, v3 offset:27904
    s_waitcnt lgkmcnt(0)
    v_add_f32 v32, v32, v40
    v_add_f32 v24, v24, v32
    v_add_f32 v33, v33, v41
    v_add_f32 v25, v25, v33
    v_add_f32 v34, v34, v42
    v_add_f32 v26, v26, v34
    v_add_f32 v35, v35, v43
    v_add_f32 v27, v27, v35
    v_add_f32 v36, v36, v44
    v_add_f32 v28, v28, v36
    v_add_f32 v37, v37, v45
    v_add_f32 v29, v29, v37
    v_add_f32 v38, v38, v46
    v_add_f32 v30, v30, v38
    v_add_f32 v39, v39, v47
    v_add_f32 v31, v31, v39
    v_add_f32 v60, v60, v68
    v_add_f32 v52, v52, v60
    v_add_f32 v61, v61, v69
    v_add_f32 v53, v53, v61
    v_add_f32 v62, v62, v70
    v_add_f32 v54, v54, v62
    v_add_f32 v63, v63, v71
    v_add_f32 v55, v55, v63
    v_add_f32 v64, v64, v72
    v_add_f32 v56, v56, v64
    v_add_f32 v65, v65, v73
    v_add_f32 v57, v57, v65
    v_add_f32 v66, v66, v74
    v_add_f32 v58, v58, v66
    v_add_f32 v67, v67, v75
    v_add_f32 v59, v59, v67
    s_mov_b32 exec_lo, -1
    s_lshl_b32 s8, s3, 2
    s_add_u32 s8, s8, 161840
    v_mov_b32 v2, s8
    v_mov_b32 v3, s42
    ds_write_b32 v2, v3
    v_lshlrev_b32 v0, 16, v0
    s_lshl_b32 s10, s2, 1
    s_add_u32 s10, s10, s5
    s_lshl_b32 s10, s10, 12
    s_lshl_b32 s11, s4, 7
    s_add_u32 s10, s10, s11
    s_add_u32 s10, s10, 4194304
    v_lshlrev_b32 v16, 8, v16
    v_lshl_add_u32 v16, v17, 4, v16
    v_lshlrev_b32 v32, 16, v48
    v_and_b32 v33, s14, v48
    v_fmac_f32 v31, v0, v32
    v_fmac_f32 v30, v0, v33
    v_lshlrev_b32 v32, 16, v49
    v_and_b32 v33, s14, v49
    v_fmac_f32 v29, v0, v32
    v_fmac_f32 v28, v0, v33
    v_lshlrev_b32 v32, 16, v50
    v_and_b32 v33, s14, v50
    v_fmac_f32 v27, v0, v32
    v_fmac_f32 v26, v0, v33
    v_lshlrev_b32 v32, 16, v51
    v_and_b32 v33, s14, v51
    v_fmac_f32 v25, v0, v32
    v_fmac_f32 v24, v0, v33
    v_cvt_pk_bf16_f32 v36, v24, v25
    v_cvt_pk_bf16_f32 v37, v26, v27
    v_cvt_pk_bf16_f32 v38, v28, v29
    v_cvt_pk_bf16_f32 v39, v30, v31
    buffer_store_dwordx4 v[36:39], v16, s[52:55], s10 offen offset:0 sc1
    v_lshlrev_b32 v60, 16, v76
    v_and_b32 v61, s14, v76
    v_fmac_f32 v59, v0, v60
    v_fmac_f32 v58, v0, v61
    v_lshlrev_b32 v60, 16, v77
    v_and_b32 v61, s14, v77
    v_fmac_f32 v57, v0, v60
    v_fmac_f32 v56, v0, v61
    v_lshlrev_b32 v60, 16, v78
    v_and_b32 v61, s14, v78
    v_fmac_f32 v55, v0, v60
    v_fmac_f32 v54, v0, v61
    v_lshlrev_b32 v60, 16, v79
    v_and_b32 v61, s14, v79
    v_fmac_f32 v53, v0, v60
    v_fmac_f32 v52, v0, v61
    v_cvt_pk_bf16_f32 v64, v52, v53
    v_cvt_pk_bf16_f32 v65, v54, v55
    v_cvt_pk_bf16_f32 v66, v56, v57
    v_cvt_pk_bf16_f32 v67, v58, v59
    buffer_store_dwordx4 v[64:67], v16, s[52:55], s10 offen offset:64 sc1
    s_nop 1
    s_waitcnt vmcnt(0)
    v_mov_b32 v15, 161920
    v_mov_b32 v4, 1
    s_mov_b64 exec, 1
    ds_add_rtn_u32 v4, v15, v4
    s_mov_b64 exec, -1
    s_waitcnt lgkmcnt(0)
    v_readfirstlane_b32 s8, v4
    s_cmp_lg_u32 s8, 3
    s_cbranch_scc1 Lfy_32
    s_lshl_b32 s8, s2, 2
    s_add_u32 s8, s8, 6438912
    v_mov_b32 v15, s42
    v_and_b32 v4, 7, v1
    v_lshlrev_b32 v4, 10, v4
    buffer_store_dword v15, v4, s[52:55], s8 offen sc1
    s_lshl_b32 s94, s93, 7
    s_and_b32 s8, s92, 7
    s_lshl_b32 s8, s8, 10
    s_add_u32 s94, s94, s8
    s_add_u32 s94, s94, 6438912
    v_and_b32 v14, 124, v13
    s_mov_b32 s9, 0
Lfyc_33:
    s_sleep 12
    buffer_load_dword v16, v14, s[52:55], s94 offen sc1
    s_waitcnt vmcnt(0)
    v_cmp_ne_u32 vcc, s42, v16
    s_cbranch_vccz Lfyok_34
    s_add_u32 s9, s9, 1
    s_cmp_gt_u32 s9, 20000
    s_cbranch_scc1 Lfyok_34
    s_branch Lfyc_33
Lfyok_34:
    v_lshrrev_b32 v15, 3, v1
    v_lshlrev_b32 v15, 12, v15
    v_and_b32 v16, 7, v1
    v_lshl_add_u32 v15, v16, 4, v15
    s_lshl_b32 s9, s93, 18
    s_lshl_b32 s10, s92, 7
    s_add_u32 s9, s9, s10
    s_add_u32 s9, s9, 4194304
    s_mov_b32 m0, 147456
    s_add_u32 s10, s9, 0
    buffer_load_dwordx4 v15, s[52:55], s10 offen sc1 lds
    s_mov_b32 m0, 148496
    s_add_u32 s10, s9, 32768
    buffer_load_dwordx4 v15, s[52:55], s10 offen sc1 lds
    s_mov_b32 m0, 149536
    s_add_u32 s10, s9, 65536
    buffer_load_dwordx4 v15, s[52:55], s10 offen sc1 lds
    s_mov_b32 m0, 150576
    s_add_u32 s10, s9, 98304
    buffer_load_dwordx4 v15, s[52:55], s10 offen sc1 lds
    s_mov_b32 m0, 151616
    s_add_u32 s10, s9, 131072
    buffer_load_dwordx4 v15, s[52:55], s10 offen sc1 lds
    s_mov_b32 m0, 152656
    s_add_u32 s10, s9, 163840
    buffer_load_dwordx4 v15, s[52:55], s10 offen sc1 lds
    s_mov_b32 m0, 153696
    s_add_u32 s10, s9, 196608
    buffer_load_dwordx4 v15, s[52:55], s10 offen sc1 lds
    s_mov_b32 m0, 154736
    s_add_u32 s10, s9, 229376
    buffer_load_dwordx4 v15, s[52:55], s10 offen sc1 lds
Lfy_32:
    v_mov_b32 v2, 161936
    s_mov_b32 s9, 0
Llw_35:
    ds_read_b32 v3, v2
    s_waitcnt lgkmcnt(0)
    v_cmp_ne_u32 vcc, s42, v3
    s_cbranch_vccz Llwok_36
    s_add_u32 s9, s9, 1
    s_cmp_lt_u32 s9, 10000000
    s_cbranch_scc1 Llw_35
Llwok_36:
    v_lshrrev_b32 v0, 3, v1
    v_and_b32 v2, 7, v1
    s_lshl_b32 s8, s3, 3
    v_add_u32 v0, s8, v0
    v_mul_u32_u24 v3, 896, v0
    v_lshl_add_u32 v3, v2, 4, v3
    s_mul_i32 s43, s92, 57344
    s_lshl_b32 s9, s93, 7
    s_add_u32 s43, s43, s9
    buffer_load_dwordx4 v[8:11], v3, s[44:47], s43 offen
    s_lshl_b32 s70, s92, 10
    s_add_u32 s70, s70, 6291456
    v_lshlrev_b32 v4, 4, v0
    buffer_load_dwordx2 v[14:15], v4, s[52:55], s70 offen sc1
    s_branch Lfin_21
Lg2_20:
    ds_read_b64_tr_b16 v[208:209], v5 offset:0
    ds_read_b64_tr_b16 v[210:211], v5 offset:1024
    ds_read_b64_tr_b16 v[212:213], v6 offset:0
    ds_read_b64_tr_b16 v[214:215], v6 offset:1024
    ds_read_b64_tr_b16 v[216:217], v5 offset:2048
    ds_read_b64_tr_b16 v[218:219], v5 offset:3072
    ds_read_b64_tr_b16 v[220:221], v6 offset:2048
    ds_read_b64_tr_b16 v[222:223], v6 offset:3072
    ds_read_b64_tr_b16 v[224:225], v5 offset:16384
    ds_read_b64_tr_b16 v[226:227], v5 offset:17408
    ds_read_b64_tr_b16 v[228:229], v6 offset:16384
    ds_read_b64_tr_b16 v[230:231], v6 offset:17408
    ds_read_b64_tr_b16 v[232:233], v5 offset:18432
    ds_read_b64_tr_b16 v[234:235], v5 offset:19456
    ds_read_b64_tr_b16 v[236:237], v6 offset:18432
    ds_read_b64_tr_b16 v[238:239], v6 offset:19456
    ds_read_b64_tr_b16 v[240:241], v5 offset:32768
    ds_read_b64_tr_b16 v[242:243], v5 offset:33792
    ds_read_b64_tr_b16 v[244:245], v6 offset:32768
    ds_read_b64_tr_b16 v[246:247], v6 offset:33792
    ds_read_b64_tr_b16 v[248:249], v5 offset:34816
    ds_read_b64_tr_b16 v[250:251], v5 offset:35840
    ds_read_b64_tr_b16 v[252:253], v6 offset:34816
    ds_read_b64_tr_b16 v[254:255], v6 offset:35840
    s_cmp_lg_u32 s3, 4
    s_cbranch_scc1 Lnp_37
    s_lshl_b32 s94, s92, 8
    s_add_u32 s94, s94, 6455296
    buffer_load_dword v15, v13, s[52:55], s94 offen sc1
    s_waitcnt vmcnt(0)
    s_mov_b32 s9, 0
Lchk_39:
    v_cmp_ne_u32 vcc, s42, v15
    s_and_b32 s8, vcc_hi, 0xffffff
    s_or_b32 s8, s8, vcc_lo
    s_cmp_eq_u32 s8, 0
    s_cbranch_scc1 Lok_40
    s_add_u32 s9, s9, 1
    s_cmp_gt_u32 s9, 20000
    s_cbranch_scc1 Lok_40
    s_sleep 8
    buffer_load_dword v15, v13, s[52:55], s94 offen sc1
    s_waitcnt vmcnt(0)
    s_branch Lchk_39
Lok_40:
    v_mov_b32 v2, 161936
    v_mov_b32 v3, s42
    ds_write_b32 v2, v3
    s_branch Lfj_38
Lnp_37:
    v_mov_b32 v2, 161936
    s_mov_b32 s9, 0
Llw_41:
    ds_read_b32 v3, v2
    s_waitcnt lgkmcnt(0)
    v_cmp_ne_u32 vcc, s42, v3
    s_cbranch_vccz Llwok_42
    s_add_u32 s9, s9, 1
    s_cmp_lt_u32 s9, 10000000
    s_cbranch_scc1 Llw_41
Llwok_42:
Lfj_38:
    s_lshl_b32 s9, s98, 10
    s_mul_i32 s88, s92, 229632
    s_add_u32 s88, s88, s9
    s_add_u32 s88, s88, 8388608
    s_add_u32 s89, s88, 114816
    s_waitcnt lgkmcnt(0)
    s_add_u32 s8, s88, 0
    buffer_load_dwordx4 v[80:83], v12, s[52:55], s8 offen sc1
    s_add_u32 s8, s89, 0
    buffer_load_dwordx4 v[84:87], v12, s[52:55], s8 offen sc1
    s_add_u32 s8, s88, 1024
    buffer_load_dwordx4 v[88:91], v12, s[52:55], s8 offen sc1
    s_add_u32 s8, s89, 1024
    buffer_load_dwordx4 v[92:95], v12, s[52:55], s8 offen sc1
    s_add_u32 s8, s88, 2048
    buffer_load_dwordx4 v[96:99], v12, s[52:55], s8 offen sc1
    s_add_u32 s8, s89, 2048
    buffer_load_dwordx4 v[100:103], v12, s[52:55], s8 offen sc1
    s_add_u32 s8, s88, 3072
    buffer_load_dwordx4 v[104:107], v12, s[52:55], s8 offen sc1
    s_add_u32 s8, s89, 3072
    buffer_load_dwordx4 v[108:111], v12, s[52:55], s8 offen sc1
    s_add_u32 s8, s88, 4096
    buffer_load_dwordx4 v[112:115], v12, s[52:55], s8 offen sc1
    s_add_u32 s8, s89, 4096
    buffer_load_dwordx4 v[116:119], v12, s[52:55], s8 offen sc1
    s_add_u32 s8, s88, 5120
    buffer_load_dwordx4 v[120:123], v12, s[52:55], s8 offen sc1
    s_add_u32 s8, s89, 5120
    buffer_load_dwordx4 v[124:127], v12, s[52:55], s8 offen sc1
    s_add_u32 s8, s88, 6144
    buffer_load_dwordx4 v[128:131], v12, s[52:55], s8 offen sc1
    s_add_u32 s8, s89, 6144
    buffer_load_dwordx4 v[132:135], v12, s[52:55], s8 offen sc1
    s_add_u32 s8, s88, 7168
    buffer_load_dwordx4 v[136:139], v12, s[52:55], s8 offen sc1
    s_add_u32 s8, s89, 7168
    buffer_load_dwordx4 v[140:143], v12, s[52:55], s8 offen sc1
    s_waitcnt vmcnt(14)
    v_mfma_f32_32x32x16_bf16 v[16:31], v[144:147], v[80:83], 0
    v_mfma_f32_32x32x16_bf16 v[32:47], v[144:147], v[84:87], 0
    s_add_u32 s8, s98, 0
    s_lshr_b32 s9, s8, 2
    s_lshl_b32 s9, s9, 2
    s_add_u32 s8, s8, s9
    s_mul_i32 s8, s8, 14336
    s_add_u32 s8, s8, s69
    s_add_u32 m0, s99, 49152
    s_add_u32 s9, s8, 57344
    buffer_load_dwordx4 v9, s[76:79], s9 offen lds
    s_add_u32 m0, s99, 50176
    s_add_u32 s9, s8, 64512
    buffer_load_dwordx4 v9, s[76:79], s9 offen lds
    v_mfma_f32_32x32x16_bf16 v[48:63], v[148:151], v[80:83], 0
    v_mfma_f32_32x32x16_bf16 v[64:79], v[148:151], v[84:87], 0
    s_add_u32 s8, s88, 8192
    buffer_load_dwordx4 v[80:83], v12, s[52:55], s8 offen sc1
    s_add_u32 s8, s89, 8192
    buffer_load_dwordx4 v[84:87], v12, s[52:55], s8 offen sc1
    s_waitcnt vmcnt(16)
    v_mfma_f32_32x32x16_bf16 v[16:31], v[152:155], v[88:91], v[16:31]
    v_mfma_f32_32x32x16_bf16 v[32:47], v[152:155], v[92:95], v[32:47]
    s_add_u32 s8, s98, 1
    s_lshr_b32 s9, s8, 2
    s_lshl_b32 s9, s9, 2
    s_add_u32 s8, s8, s9
    s_mul_i32 s8, s8, 14336
    s_add_u32 s8, s8, s69
    s_add_u32 m0, s99, 51200
    s_add_u32 s9, s8, 57344
    buffer_load_dwordx4 v9, s[76:79], s9 offen lds
    s_add_u32 m0, s99, 52224
    s_add_u32 s9, s8, 64512
    buffer_load_dwordx4 v9, s[76:79], s9 offen lds
    v_mfma_f32_32x32x16_bf16 v[48:63], v[156:159], v[88:91], v[48:63]
    v_mfma_f32_32x32x16_bf16 v[64:79], v[156:159], v[92:95], v[64:79]
    s_add_u32 s8, s88, 9216
    buffer_load_dwordx4 v[88:91], v12, s[52:55], s8 offen sc1
    s_add_u32 s8, s89, 9216
    buffer_load_dwordx4 v[92:95], v12, s[52:55], s8 offen sc1
    s_waitcnt vmcnt(18)
    v_mfma_f32_32x32x16_bf16 v[16:31], v[160:163], v[96:99], v[16:31]
    v_mfma_f32_32x32x16_bf16 v[32:47], v[160:163], v[100:103], v[32:47]
    s_add_u32 s8, s98, 2
    s_lshr_b32 s9, s8, 2
    s_lshl_b32 s9, s9, 2
    s_add_u32 s8, s8, s9
    s_mul_i32 s8, s8, 14336
    s_add_u32 s8, s8, s69
    s_add_u32 m0, s99, 65536
    s_add_u32 s9, s8, 57344
    buffer_load_dwordx4 v9, s[76:79], s9 offen lds
    s_add_u32 m0, s99, 66560
    s_add_u32 s9, s8, 64512
    buffer_load_dwordx4 v9, s[76:79], s9 offen lds
    v_mfma_f32_32x32x16_bf16 v[48:63], v[164:167], v[96:99], v[48:63]
    v_mfma_f32_32x32x16_bf16 v[64:79], v[164:167], v[100:103], v[64:79]
    s_add_u32 s8, s88, 10240
    buffer_load_dwordx4 v[96:99], v12, s[52:55], s8 offen sc1
    s_add_u32 s8, s89, 10240
    buffer_load_dwordx4 v[100:103], v12, s[52:55], s8 offen sc1
    s_waitcnt vmcnt(20)
    v_mfma_f32_32x32x16_bf16 v[16:31], v[168:171], v[104:107], v[16:31]
    v_mfma_f32_32x32x16_bf16 v[32:47], v[168:171], v[108:111], v[32:47]
    s_add_u32 s8, s98, 3
    s_lshr_b32 s9, s8, 2
    s_lshl_b32 s9, s9, 2
    s_add_u32 s8, s8, s9
    s_mul_i32 s8, s8, 14336
    s_add_u32 s8, s8, s69
    s_add_u32 m0, s99, 67584
    s_add_u32 s9, s8, 57344
    buffer_load_dwordx4 v9, s[76:79], s9 offen lds
    s_add_u32 m0, s99, 68608
    s_add_u32 s9, s8, 64512
    buffer_load_dwordx4 v9, s[76:79], s9 offen lds
    v_mfma_f32_32x32x16_bf16 v[48:63], v[172:175], v[104:107], v[48:63]
    v_mfma_f32_32x32x16_bf16 v[64:79], v[172:175], v[108:111], v[64:79]
    s_add_u32 s8, s88, 11264
    buffer_load_dwordx4 v[104:107], v12, s[52:55], s8 offen sc1
    s_add_u32 s8, s89, 11264
    buffer_load_dwordx4 v[108:111], v12, s[52:55], s8 offen sc1
    s_waitcnt vmcnt(22)
    v_mfma_f32_32x32x16_bf16 v[16:31], v[176:179], v[112:115], v[16:31]
    v_mfma_f32_32x32x16_bf16 v[32:47], v[176:179], v[116:119], v[32:47]
    s_add_u32 s8, s98, 4
    s_lshr_b32 s9, s8, 2
    s_lshl_b32 s9, s9, 2
    s_add_u32 s8, s8, s9
    s_mul_i32 s8, s8, 14336
    s_add_u32 s8, s8, s69
    s_add_u32 m0, s99, 0
    s_add_u32 s9, s8, 57344
    buffer_load_dwordx4 v9, s[76:79], s9 offen lds
    s_add_u32 m0, s99, 1024
    s_add_u32 s9, s8, 64512
    buffer_load_dwordx4 v9, s[76:79], s9 offen lds
    v_mfma_f32_32x32x16_bf16 v[48:63], v[180:183], v[112:115], v[48:63]
    v_mfma_f32_32x32x16_bf16 v[64:79], v[180:183], v[116:119], v[64:79]
    s_add_u32 s8, s88, 12288
    buffer_load_dwordx4 v[112:115], v12, s[52:55], s8 offen sc1
    s_add_u32 s8, s89, 12288
    buffer_load_dwordx4 v[116:119], v12, s[52:55], s8 offen sc1
    s_waitcnt vmcnt(24)
    v_mfma_f32_32x32x16_bf16 v[16:31], v[184:187], v[120:123], v[16:31]
    v_mfma_f32_32x32x16_bf16 v[32:47], v[184:187], v[124:127], v[32:47]
    s_add_u32 s8, s98, 5
    s_lshr_b32 s9, s8, 2
    s_lshl_b32 s9, s9, 2
    s_add_u32 s8, s8, s9
    s_mul_i32 s8, s8, 14336
    s_add_u32 s8, s8, s69
    s_add_u32 m0, s99, 2048
    s_add_u32 s9, s8, 57344
    buffer_load_dwordx4 v9, s[76:79], s9 offen lds
    s_add_u32 m0, s99, 3072
    s_add_u32 s9, s8, 64512
    buffer_load_dwordx4 v9, s[76:79], s9 offen lds
    v_mfma_f32_32x32x16_bf16 v[48:63], v[188:191], v[120:123], v[48:63]
    v_mfma_f32_32x32x16_bf16 v[64:79], v[188:191], v[124:127], v[64:79]
    s_add_u32 s8, s88, 13312
    buffer_load_dwordx4 v[120:123], v12, s[52:55], s8 offen sc1
    s_add_u32 s8, s89, 13312
    buffer_load_dwordx4 v[124:127], v12, s[52:55], s8 offen sc1
    s_cmp_lg_u32 s3, 4
    s_cbranch_scc1 Lnp_43
    s_lshl_b32 s94, s92, 8
    s_add_u32 s94, s94, 6463488
    buffer_load_dword v15, v13, s[52:55], s94 offen sc1
    s_waitcnt vmcnt(0)
    s_mov_b32 s9, 0
Lchk_45:
    v_cmp_ne_u32 vcc, s42, v15
    s_and_b32 s8, vcc_hi, 0xffffff
    s_or_b32 s8, s8, vcc_lo
    s_cmp_eq_u32 s8, 0
    s_cbranch_scc1 Lok_46
    s_add_u32 s9, s9, 1
    s_cmp_gt_u32 s9, 20000
    s_cbranch_scc1 Lok_46
    s_sleep 8
    buffer_load_dword v15, v13, s[52:55], s94 offen sc1
    s_waitcnt vmcnt(0)
    s_branch Lchk_45
Lok_46:
    v_mov_b32 v2, 161940
    v_mov_b32 v3, s42
    ds_write_b32 v2, v3
    s_branch Lfj_44
Lnp_43:
    v_mov_b32 v2, 161940
    s_mov_b32 s9, 0
Llw_47:
    ds_read_b32 v3, v2
    s_waitcnt lgkmcnt(0)
    v_cmp_ne_u32 vcc, s42, v3
    s_cbranch_vccz Llwok_48
    s_add_u32 s9, s9, 1
    s_cmp_lt_u32 s9, 10000000
    s_cbranch_scc1 Llw_47
Llwok_48:
Lfj_44:
    s_waitcnt vmcnt(26)
    v_mfma_f32_32x32x16_bf16 v[16:31], v[192:195], v[128:131], v[16:31]
    v_mfma_f32_32x32x16_bf16 v[32:47], v[192:195], v[132:135], v[32:47]
    s_add_u32 s8, s98, 6
    s_lshr_b32 s9, s8, 2
    s_lshl_b32 s9, s9, 2
    s_add_u32 s8, s8, s9
    s_mul_i32 s8, s8, 14336
    s_add_u32 s8, s8, s69
    s_add_u32 m0, s99, 16384
    s_add_u32 s9, s8, 57344
    buffer_load_dwordx4 v9, s[76:79], s9 offen lds
    s_add_u32 m0, s99, 17408
    s_add_u32 s9, s8, 64512
    buffer_load_dwordx4 v9, s[76:79], s9 offen lds
    v_mfma_f32_32x32x16_bf16 v[48:63], v[196:199], v[128:131], v[48:63]
    v_mfma_f32_32x32x16_bf16 v[64:79], v[196:199], v[132:135], v[64:79]
    s_add_u32 s8, s88, 57344
    buffer_load_dwordx4 v[128:131], v12, s[52:55], s8 offen sc1
    s_add_u32 s8, s89, 57344
    buffer_load_dwordx4 v[132:135], v12, s[52:55], s8 offen sc1
    s_waitcnt vmcnt(28)
    v_mfma_f32_32x32x16_bf16 v[16:31], v[200:203], v[136:139], v[16:31]
    v_mfma_f32_32x32x16_bf16 v[32:47], v[200:203], v[140:143], v[32:47]
    s_add_u32 s8, s98, 7
    s_lshr_b32 s9, s8, 2
    s_lshl_b32 s9, s9, 2
    s_add_u32 s8, s8, s9
    s_mul_i32 s8, s8, 14336
    s_add_u32 s8, s8, s69
    s_add_u32 m0, s99, 18432
    s_add_u32 s9, s8, 57344
    buffer_load_dwordx4 v9, s[76:79], s9 offen lds
    s_add_u32 m0, s99, 19456
    s_add_u32 s9, s8, 64512
    buffer_load_dwordx4 v9, s[76:79], s9 offen lds
    v_mfma_f32_32x32x16_bf16 v[48:63], v[204:207], v[136:139], v[48:63]
    v_mfma_f32_32x32x16_bf16 v[64:79], v[204:207], v[140:143], v[64:79]
    s_add_u32 s8, s88, 58368
    buffer_load_dwordx4 v[136:139], v12, s[52:55], s8 offen sc1
    s_add_u32 s8, s89, 58368
    buffer_load_dwordx4 v[140:143], v12, s[52:55], s8 offen sc1
    s_waitcnt vmcnt(28)
    v_mfma_f32_32x32x16_bf16 v[16:31], v[208:211], v[80:83], v[16:31]
    v_mfma_f32_32x32x16_bf16 v[32:47], v[208:211], v[84:87], v[32:47]
    s_add_u32 s8, s98, 8
    s_lshr_b32 s9, s8, 2
    s_lshl_b32 s9, s9, 2
    s_add_u32 s8, s8, s9
    s_mul_i32 s8, s8, 14336
    s_add_u32 s8, s8, s69
    s_add_u32 m0, s99, 32768
    s_add_u32 s9, s8, 57344
    buffer_load_dwordx4 v9, s[76:79], s9 offen lds
    s_add_u32 m0, s99, 33792
    s_add_u32 s9, s8, 64512
    buffer_load_dwordx4 v9, s[76:79], s9 offen lds
    v_mfma_f32_32x32x16_bf16 v[48:63], v[212:215], v[80:83], v[48:63]
    v_mfma_f32_32x32x16_bf16 v[64:79], v[212:215], v[84:87], v[64:79]
    s_add_u32 s8, s88, 59392
    buffer_load_dwordx4 v[80:83], v12, s[52:55], s8 offen sc1
    s_add_u32 s8, s89, 59392
    buffer_load_dwordx4 v[84:87], v12, s[52:55], s8 offen sc1
    s_waitcnt vmcnt(28)
    v_mfma_f32_32x32x16_bf16 v[16:31], v[216:219], v[88:91], v[16:31]
    v_mfma_f32_32x32x16_bf16 v[32:47], v[216:219], v[92:95], v[32:47]
    s_add_u32 s8, s98, 9
    s_lshr_b32 s9, s8, 2
    s_lshl_b32 s9, s9, 2
    s_add_u32 s8, s8, s9
    s_mul_i32 s8, s8, 14336
    s_add_u32 s8, s8, s69
    s_add_u32 m0, s99, 34816
    s_add_u32 s9, s8, 57344
    buffer_load_dwordx4 v9, s[76:79], s9 offen lds
    s_add_u32 m0, s99, 35840
    s_add_u32 s9, s8, 64512
    buffer_load_dwordx4 v9, s[76:79], s9 offen lds
    v_mfma_f32_32x32x16_bf16 v[48:63], v[220:223], v[88:91], v[48:63]
    v_mfma_f32_32x32x16_bf16 v[64:79], v[220:223], v[92:95], v[64:79]
    s_add_u32 s8, s88, 60416
    buffer_load_dwordx4 v[88:91], v12, s[52:55], s8 offen sc1
    s_add_u32 s8, s89, 60416
    buffer_load_dwordx4 v[92:95], v12, s[52:55], s8 offen sc1
    s_waitcnt vmcnt(28)
    v_mfma_f32_32x32x16_bf16 v[16:31], v[224:227], v[96:99], v[16:31]
    v_mfma_f32_32x32x16_bf16 v[32:47], v[224:227], v[100:103], v[32:47]
    v_mfma_f32_32x32x16_bf16 v[48:63], v[228:231], v[96:99], v[48:63]
    v_mfma_f32_32x32x16_bf16 v[64:79], v[228:231], v[100:103], v[64:79]
    s_add_u32 s8, s88, 61440
    buffer_load_dwordx4 v[96:99], v12, s[52:55], s8 offen sc1
    s_add_u32 s8, s89, 61440
    buffer_load_dwordx4 v[100:103], v12, s[52:55], s8 offen sc1
    s_waitcnt vmcnt(26)
    s_waitcnt vmcnt(40)
    v_mfma_f32_32x32x16_bf16 v[16:31], v[232:235], v[104:107], v[16:31]
    ds_read_b64_tr_b16 v[144:145], v5 offset:49152
    v_mfma_f32_32x32x16_bf16 v[32:47], v[232:235], v[108:111], v[32:47]
    ds_read_b64_tr_b16 v[146:147], v5 offset:50176
    v_mfma_f32_32x32x16_bf16 v[48:63], v[236:239], v[104:107], v[48:63]
    ds_read_b64_tr_b16 v[148:149], v6 offset:49152
    v_mfma_f32_32x32x16_bf16 v[64:79], v[236:239], v[108:111], v[64:79]
    ds_read_b64_tr_b16 v[150:151], v6 offset:50176
    s_add_u32 s8, s88, 62464
    buffer_load_dwordx4 v[104:107], v12, s[52:55], s8 offen sc1
    s_add_u32 s8, s89, 62464
    buffer_load_dwordx4 v[108:111], v12, s[52:55], s8 offen sc1
    s_waitcnt vmcnt(24)
    s_waitcnt vmcnt(38)
    v_mfma_f32_32x32x16_bf16 v[16:31], v[240:243], v[112:115], v[16:31]
    ds_read_b64_tr_b16 v[152:153], v5 offset:51200
    v_mfma_f32_32x32x16_bf16 v[32:47], v[240:243], v[116:119], v[32:47]
    ds_read_b64_tr_b16 v[154:155], v5 offset:52224
    v_mfma_f32_32x32x16_bf16 v[48:63], v[244:247], v[112:115], v[48:63]
    ds_read_b64_tr_b16 v[156:157], v6 offset:51200
    v_mfma_f32_32x32x16_bf16 v[64:79], v[244:247], v[116:119], v[64:79]
    ds_read_b64_tr_b16 v[158:159], v6 offset:52224
    s_add_u32 s8, s88, 63488
    buffer_load_dwordx4 v[112:115], v12, s[52:55], s8 offen sc1
    s_add_u32 s8, s89, 63488
    buffer_load_dwordx4 v[116:119], v12, s[52:55], s8 offen sc1
    s_waitcnt vmcnt(22)
    s_waitcnt vmcnt(36)
    v_mfma_f32_32x32x16_bf16 v[16:31], v[248:251], v[120:123], v[16:31]
    ds_read_b64_tr_b16 v[160:161], v7 offset:0
    v_mfma_f32_32x32x16_bf16 v[32:47], v[248:251], v[124:127], v[32:47]
    ds_read_b64_tr_b16 v[162:163], v7 offset:1024
    v_mfma_f32_32x32x16_bf16 v[48:63], v[252:255], v[120:123], v[48:63]
    ds_read_b64_tr_b16 v[164:165], v8 offset:0
    v_mfma_f32_32x32x16_bf16 v[64:79], v[252:255], v[124:127], v[64:79]
    ds_read_b64_tr_b16 v[166:167], v8 offset:1024
    s_add_u32 s8, s88, 64512
    buffer_load_dwordx4 v[120:123], v12, s[52:55], s8 offen sc1
    s_add_u32 s8, s89, 64512
    buffer_load_dwordx4 v[124:127], v12, s[52:55], s8 offen sc1
    s_waitcnt vmcnt(20)
    s_waitcnt lgkmcnt(8)
    s_waitcnt vmcnt(34)
    v_mfma_f32_32x32x16_bf16 v[16:31], v[144:147], v[128:131], v[16:31]
    ds_read_b64_tr_b16 v[168:169], v7 offset:2048
    v_mfma_f32_32x32x16_bf16 v[32:47], v[144:147], v[132:135], v[32:47]
    ds_read_b64_tr_b16 v[170:171], v7 offset:3072
    v_mfma_f32_32x32x16_bf16 v[48:63], v[148:151], v[128:131], v[48:63]
    ds_read_b64_tr_b16 v[172:173], v8 offset:2048
    v_mfma_f32_32x32x16_bf16 v[64:79], v[148:151], v[132:135], v[64:79]
    ds_read_b64_tr_b16 v[174:175], v8 offset:3072
    s_add_u32 s8, s88, 65536
    buffer_load_dwordx4 v[128:131], v12, s[52:55], s8 offen sc1
    s_add_u32 s8, s89, 65536
    buffer_load_dwordx4 v[132:135], v12, s[52:55], s8 offen sc1
    s_waitcnt vmcnt(18)
    s_waitcnt lgkmcnt(8)
    s_waitcnt vmcnt(32)
    v_mfma_f32_32x32x16_bf16 v[16:31], v[152:155], v[136:139], v[16:31]
    ds_read_b64_tr_b16 v[176:177], v5 offset:0
    v_mfma_f32_32x32x16_bf16 v[32:47], v[152:155], v[140:143], v[32:47]
    ds_read_b64_tr_b16 v[178:179], v5 offset:1024
    v_mfma_f32_32x32x16_bf16 v[48:63], v[156:159], v[136:139], v[48:63]
    ds_read_b64_tr_b16 v[180:181], v6 offset:0
    v_mfma_f32_32x32x16_bf16 v[64:79], v[156:159], v[140:143], v[64:79]
    ds_read_b64_tr_b16 v[182:183], v6 offset:1024
    s_add_u32 s8, s88, 66560
    buffer_load_dwordx4 v[136:139], v12, s[52:55], s8 offen sc1
    s_add_u32 s8, s89, 66560
    buffer_load_dwordx4 v[140:143], v12, s[52:55], s8 offen sc1
    s_waitcnt vmcnt(16)
    s_waitcnt lgkmcnt(8)
    s_waitcnt vmcnt(30)
    v_mfma_f32_32x32x16_bf16 v[16:31], v[160:163], v[80:83], v[16:31]
    ds_read_b64_tr_b16 v[184:185], v5 offset:2048
    v_mfma_f32_32x32x16_bf16 v[32:47], v[160:163], v[84:87], v[32:47]
    ds_read_b64_tr_b16 v[186:187], v5 offset:3072
    s_add_u32 s8, s98, 10
    s_lshr_b32 s9, s8, 2
    s_lshl_b32 s9, s9, 2
    s_add_u32 s8, s8, s9
    s_mul_i32 s8, s8, 14336
    s_add_u32 s8, s8, s69
    s_add_u32 m0, s99, 49152
    s_add_u32 s9, s8, 57344
    buffer_load_dwordx4 v9, s[76:79], s9 offen lds
    s_add_u32 m0, s99, 50176
    s_add_u32 s9, s8, 64512
    buffer_load_dwordx4 v9, s[76:79], s9 offen lds
    v_mfma_f32_32x32x16_bf16 v[48:63], v[164:167], v[80:83], v[48:63]
    ds_read_b64_tr_b16 v[188:189], v6 offset:2048
    v_mfma_f32_32x32x16_bf16 v[64:79], v[164:167], v[84:87], v[64:79]
    ds_read_b64_tr_b16 v[190:191], v6 offset:3072
    s_add_u32 s8, s88, 67584
    buffer_load_dwordx4 v[80:83], v12, s[52:55], s8 offen sc1
    s_add_u32 s8, s89, 67584
    buffer_load_dwordx4 v[84:87], v12, s[52:55], s8 offen sc1
    s_waitcnt vmcnt(16)
    s_waitcnt lgkmcnt(8)
    s_waitcnt vmcnt(30)
    v_mfma_f32_32x32x16_bf16 v[16:31], v[168:171], v[88:91], v[16:31]
    ds_read_b64_tr_b16 v[192:193], v5 offset:16384
    v_mfma_f32_32x32x16_bf16 v[32:47], v[168:171], v[92:95], v[32:47]
    ds_read_b64_tr_b16 v[194:195], v5 offset:17408
    s_add_u32 s8, s98, 11
    s_lshr_b32 s9, s8, 2
    s_lshl_b32 s9, s9, 2
    s_add_u32 s8, s8, s9
    s_mul_i32 s8, s8, 14336
    s_add_u32 s8, s8, s69
    s_add_u32 m0, s99, 51200
    s_add_u32 s9, s8, 57344
    buffer_load_dwordx4 v9, s[76:79], s9 offen lds
    s_add_u32 m0, s99, 52224
    s_add_u32 s9, s8, 64512
    buffer_load_dwordx4 v9, s[76:79], s9 offen lds
    v_mfma_f32_32x32x16_bf16 v[48:63], v[172:175], v[88:91], v[48:63]
    ds_read_b64_tr_b16 v[196:197], v6 offset:16384
    v_mfma_f32_32x32x16_bf16 v[64:79], v[172:175], v[92:95], v[64:79]
    ds_read_b64_tr_b16 v[198:199], v6 offset:17408
    s_add_u32 s8, s88, 68608
    buffer_load_dwordx4 v[88:91], v12, s[52:55], s8 offen sc1
    s_add_u32 s8, s89, 68608
    buffer_load_dwordx4 v[92:95], v12, s[52:55], s8 offen sc1
    s_waitcnt vmcnt(18)
    s_waitcnt lgkmcnt(8)
    s_waitcnt vmcnt(30)
    v_mfma_f32_32x32x16_bf16 v[16:31], v[176:179], v[96:99], v[16:31]
    ds_read_b64_tr_b16 v[200:201], v5 offset:18432
    v_mfma_f32_32x32x16_bf16 v[32:47], v[176:179], v[100:103], v[32:47]
    ds_read_b64_tr_b16 v[202:203], v5 offset:19456
    s_add_u32 s8, s98, 12
    s_lshr_b32 s9, s8, 2
    s_lshl_b32 s9, s9, 2
    s_add_u32 s8, s8, s9
    s_mul_i32 s8, s8, 14336
    s_add_u32 s8, s8, s69
    s_add_u32 m0, s99, 65536
    s_add_u32 s9, s8, 57344
    buffer_load_dwordx4 v9, s[76:79], s9 offen lds
    s_add_u32 m0, s99, 66560
    s_add_u32 s9, s8, 64512
    buffer_load_dwordx4 v9, s[76:79], s9 offen lds
    v_mfma_f32_32x32x16_bf16 v[48:63], v[180:183], v[96:99], v[48:63]
    ds_read_b64_tr_b16 v[204:205], v6 offset:18432
    v_mfma_f32_32x32x16_bf16 v[64:79], v[180:183], v[100:103], v[64:79]
    ds_read_b64_tr_b16 v[206:207], v6 offset:19456
    s_add_u32 s8, s88, 69632
    buffer_load_dwordx4 v[96:99], v12, s[52:55], s8 offen sc1
    s_add_u32 s8, s89, 69632
    buffer_load_dwordx4 v[100:103], v12, s[52:55], s8 offen sc1
    s_waitcnt vmcnt(20)
    s_waitcnt lgkmcnt(8)
    s_waitcnt vmcnt(30)
    v_mfma_f32_32x32x16_bf16 v[16:31], v[184:187], v[104:107], v[16:31]
    ds_read_b64_tr_b16 v[208:209], v5 offset:32768
    v_mfma_f32_32x32x16_bf16 v[32:47], v[184:187], v[108:111], v[32:47]
    ds_read_b64_tr_b16 v[210:211], v5 offset:33792
    s_add_u32 s8, s98, 13
    s_lshr_b32 s9, s8, 2
    s_lshl_b32 s9, s9, 2
    s_add_u32 s8, s8, s9
    s_mul_i32 s8, s8, 14336
    s_add_u32 s8, s8, s69
    s_add_u32 m0, s99, 67584
    s_add_u32 s9, s8, 57344
    buffer_load_dwordx4 v9, s[76:79], s9 offen lds
    s_add_u32 m0, s99, 68608
    s_add_u32 s9, s8, 64512
    buffer_load_dwordx4 v9, s[76:79], s9 offen lds
    v_mfma_f32_32x32x16_bf16 v[48:63], v[188:191], v[104:107], v[48:63]
    ds_read_b64_tr_b16 v[212:213], v6 offset:32768
    v_mfma_f32_32x32x16_bf16 v[64:79], v[188:191], v[108:111], v[64:79]
    ds_read_b64_tr_b16 v[214:215], v6 offset:33792
    s_add_u32 s8, s88, 70656
    buffer_load_dwordx4 v[104:107], v12, s[52:55], s8 offen sc1
    s_add_u32 s8, s89, 70656
    buffer_load_dwordx4 v[108:111], v12, s[52:55], s8 offen sc1
    s_waitcnt vmcnt(22)
    s_waitcnt lgkmcnt(8)
    s_waitcnt vmcnt(30)
    v_mfma_f32_32x32x16_bf16 v[16:31], v[192:195], v[112:115], v[16:31]
    ds_read_b64_tr_b16 v[216:217], v5 offset:34816
    v_mfma_f32_32x32x16_bf16 v[32:47], v[192:195], v[116:119], v[32:47]
    ds_read_b64_tr_b16 v[218:219], v5 offset:35840
    v_mfma_f32_32x32x16_bf16 v[48:63], v[196:199], v[112:115], v[48:63]
    ds_read_b64_tr_b16 v[220:221], v6 offset:34816
    v_mfma_f32_32x32x16_bf16 v[64:79], v[196:199], v[116:119], v[64:79]
    ds_read_b64_tr_b16 v[222:223], v6 offset:35840
    s_waitcnt vmcnt(20)
    s_waitcnt lgkmcnt(8)
    s_waitcnt vmcnt(14)
    v_mfma_f32_32x32x16_bf16 v[16:31], v[200:203], v[120:123], v[16:31]
    ds_read_b64_tr_b16 v[224:225], v5 offset:49152
    v_mfma_f32_32x32x16_bf16 v[32:47], v[200:203], v[124:127], v[32:47]
    ds_read_b64_tr_b16 v[226:227], v5 offset:50176
    v_mfma_f32_32x32x16_bf16 v[48:63], v[204:207], v[120:123], v[48:63]
    ds_read_b64_tr_b16 v[228:229], v6 offset:49152
    v_mfma_f32_32x32x16_bf16 v[64:79], v[204:207], v[124:127], v[64:79]
    ds_read_b64_tr_b16 v[230:231], v6 offset:50176
    s_waitcnt vmcnt(18)
    s_waitcnt lgkmcnt(8)
    s_waitcnt vmcnt(10)
    v_mfma_f32_32x32x16_bf16 v[16:31], v[208:211], v[128:131], v[16:31]
    ds_read_b64_tr_b16 v[232:233], v5 offset:51200
    v_mfma_f32_32x32x16_bf16 v[32:47], v[208:211], v[132:135], v[32:47]
    ds_read_b64_tr_b16 v[234:235], v5 offset:52224
    v_mfma_f32_32x32x16_bf16 v[48:63], v[212:215], v[128:131], v[48:63]
    ds_read_b64_tr_b16 v[236:237], v6 offset:51200
    v_mfma_f32_32x32x16_bf16 v[64:79], v[212:215], v[132:135], v[64:79]
    ds_read_b64_tr_b16 v[238:239], v6 offset:52224
    s_waitcnt vmcnt(16)
    s_waitcnt lgkmcnt(8)
    s_waitcnt vmcnt(6)
    v_mfma_f32_32x32x16_bf16 v[16:31], v[216:219], v[136:139], v[16:31]
    ds_read_b64_tr_b16 v[240:241], v7 offset:0
    v_mfma_f32_32x32x16_bf16 v[32:47], v[216:219], v[140:143], v[32:47]
    ds_read_b64_tr_b16 v[242:243], v7 offset:1024
    v_mfma_f32_32x32x16_bf16 v[48:63], v[220:223], v[136:139], v[48:63]
    ds_read_b64_tr_b16 v[244:245], v8 offset:0
    v_mfma_f32_32x32x16_bf16 v[64:79], v[220:223], v[140:143], v[64:79]
    ds_read_b64_tr_b16 v[246:247], v8 offset:1024
    s_waitcnt vmcnt(12)
    s_waitcnt lgkmcnt(8)
    s_waitcnt vmcnt(2)
    v_mfma_f32_32x32x16_bf16 v[16:31], v[224:227], v[80:83], v[16:31]
    ds_read_b64_tr_b16 v[248:249], v7 offset:2048
    v_mfma_f32_32x32x16_bf16 v[32:47], v[224:227], v[84:87], v[32:47]
    ds_read_b64_tr_b16 v[250:251], v7 offset:3072
    v_mfma_f32_32x32x16_bf16 v[48:63], v[228:231], v[80:83], v[48:63]
    ds_read_b64_tr_b16 v[252:253], v8 offset:2048
    v_mfma_f32_32x32x16_bf16 v[64:79], v[228:231], v[84:87], v[64:79]
    ds_read_b64_tr_b16 v[254:255], v8 offset:3072
    s_waitcnt vmcnt(8)
    s_waitcnt lgkmcnt(8)
    v_mfma_f32_32x32x16_bf16 v[16:31], v[232:235], v[88:91], v[16:31]
    v_mfma_f32_32x32x16_bf16 v[32:47], v[232:235], v[92:95], v[32:47]
    v_mfma_f32_32x32x16_bf16 v[48:63], v[236:239], v[88:91], v[48:63]
    v_mfma_f32_32x32x16_bf16 v[64:79], v[236:239], v[92:95], v[64:79]
    v_lshrrev_b32 v0, 3, v1
    v_and_b32 v2, 7, v1
    s_lshl_b32 s8, s3, 3
    v_add_u32 v0, s8, v0
    v_mul_u32_u24 v3, 896, v0
    v_lshl_add_u32 v3, v2, 4, v3
    s_mul_i32 s43, s92, 57344
    s_lshl_b32 s9, s93, 7
    s_add_u32 s43, s43, s9
    buffer_load_dwordx4 v[8:11], v3, s[44:47], s43 offen
    s_lshl_b32 s70, s92, 10
    s_add_u32 s70, s70, 6291456
    v_lshlrev_b32 v4, 4, v0
    buffer_load_dwordx2 v[14:15], v4, s[52:55], s70 offen sc1
    s_waitcnt vmcnt(6)
    s_waitcnt lgkmcnt(4)
    v_mfma_f32_32x32x16_bf16 v[16:31], v[240:243], v[96:99], v[16:31]
    v_mfma_f32_32x32x16_bf16 v[32:47], v[240:243], v[100:103], v[32:47]
    v_mfma_f32_32x32x16_bf16 v[48:63], v[244:247], v[96:99], v[48:63]
    v_mfma_f32_32x32x16_bf16 v[64:79], v[244:247], v[100:103], v[64:79]
    s_waitcnt vmcnt(2)
    s_waitcnt lgkmcnt(0)
    v_mfma_f32_32x32x16_bf16 v[16:31], v[248:251], v[104:107], v[16:31]
    v_mfma_f32_32x32x16_bf16 v[32:47], v[248:251], v[108:111], v[32:47]
    v_mfma_f32_32x32x16_bf16 v[48:63], v[252:255], v[104:107], v[48:63]
    v_mfma_f32_32x32x16_bf16 v[64:79], v[252:255], v[108:111], v[64:79]
    s_lshl_b32 s8, s3, 2
    s_add_u32 s8, s8, 161936
    v_mov_b32 v80, s8
    v_mov_b32 v81, s42
    ds_write_b32 v80, v81
    v_and_b32 v80, 3, v1
    v_lshlrev_b32 v80, 2, v80
    v_add_u32 v80, 161952, v80
    s_mov_b32 s9, 0
Llf3_49:
    ds_read_b32 v81, v80
    s_waitcnt lgkmcnt(0)
    v_cmp_ne_u32 vcc, s42, v81
    s_cbranch_vccz Llf3ok_50
    s_add_u32 s9, s9, 1
    s_cmp_lt_u32 s9, 10000000
    s_cbranch_scc1 Llf3_49
Llf3ok_50:
    v_and_b32 v80, 31, v1
    v_lshrrev_b32 v81, 5, v1
    v_mul_u32_u24 v80, 272, v80
    v_lshl_add_u32 v80, v81, 4, v80
    s_sub_u32 s8, s3, 4
    s_mul_i32 s8, s8, 17408
    v_add_u32 v80, s8, v80
    s_nop 3
    ds_write_b128 v80, v[16:19] offset:0
    ds_write_b128 v80, v[20:23] offset:32
    ds_write_b128 v80, v[24:27] offset:64
    ds_write_b128 v80, v[28:31] offset:96
    ds_write_b128 v80, v[32:35] offset:8704
    ds_write_b128 v80, v[36:39] offset:8736
    ds_write_b128 v80, v[40:43] offset:8768
    ds_write_b128 v80, v[44:47] offset:8800
    ds_write_b128 v80, v[48:51] offset:128
    ds_write_b128 v80, v[52:55] offset:160
    ds_write_b128 v80, v[56:59] offset:192
    ds_write_b128 v80, v[60:63] offset:224
    ds_write_b128 v80, v[64:67] offset:8832
    ds_write_b128 v80, v[68:71] offset:8864
    ds_write_b128 v80, v[72:75] offset:8896
    ds_write_b128 v80, v[76:79] offset:8928
Lfin_21:
    v_mul_u32_u24 v82, 1040, v2
    v_lshl_add_u32 v82, v0, 1, v82
    v_add_u32 v82, 147456, v82
    v_mul_u32_u24 v84, 272, v0
    v_lshl_add_u32 v84, v2, 5, v84
    s_waitcnt vmcnt(0) lgkmcnt(0)
    s_barrier
    ds_read_b128 v[16:19], v84 offset:0
    ds_read_b128 v[20:23], v84 offset:16
    ds_read_b128 v[24:27], v84 offset:17408
    ds_read_b128 v[28:31], v84 offset:17424
    ds_read_b128 v[32:35], v84 offset:34816
    ds_read_b128 v[36:39], v84 offset:34832
    ds_read_b128 v[40:43], v84 offset:52224
    ds_read_b128 v[44:47], v84 offset:52240
    ds_read_u16 v96, v82 offset:0
    ds_read_u16 v97, v82 offset:128
    ds_read_u16 v98, v82 offset:256
    ds_read_u16 v99, v82 offset:384
    ds_read_u16 v100, v82 offset:512
    ds_read_u16 v101, v82 offset:640
    ds_read_u16 v102, v82 offset:768
    ds_read_u16 v103, v82 offset:896
    s_mov_b32 s11, 0xbfb8aa3b
    v_lshlrev_b32 v104, 16, v8
    v_and_b32 v105, s14, v8
    v_lshlrev_b32 v106, 16, v9
    v_and_b32 v107, s14, v9
    v_lshlrev_b32 v108, 16, v10
    v_and_b32 v109, s14, v10
    v_lshlrev_b32 v110, 16, v11
    v_and_b32 v111, s14, v11
    v_mul_f32 v6, v15, v15
    v_mul_f32 v7, v14, v15
    v_fma_f32 v112, v104, v15, -v7
    v_fma_f32 v113, v105, v15, -v7
    v_fma_f32 v114, v106, v15, -v7
    v_fma_f32 v115, v107, v15, -v7
    v_fma_f32 v116, v108, v15, -v7
    v_fma_f32 v117, v109, v15, -v7
    v_fma_f32 v118, v110, v15, -v7
    v_fma_f32 v119, v111, v15, -v7
    s_waitcnt lgkmcnt(8)
    v_pk_add_f32 v[16:17], v[16:17], v[24:25]
    v_pk_add_f32 v[32:33], v[32:33], v[40:41]
    v_pk_add_f32 v[18:19], v[18:19], v[26:27]
    v_pk_add_f32 v[34:35], v[34:35], v[42:43]
    v_pk_add_f32 v[20:21], v[20:21], v[28:29]
    v_pk_add_f32 v[36:37], v[36:37], v[44:45]
    v_pk_add_f32 v[22:23], v[22:23], v[30:31]
    v_pk_add_f32 v[38:39], v[38:39], v[46:47]
    v_pk_add_f32 v[32:33], v[16:17], v[32:33]
    v_pk_add_f32 v[34:35], v[18:19], v[34:35]
    v_pk_add_f32 v[36:37], v[20:21], v[36:37]
    v_pk_add_f32 v[38:39], v[22:23], v[38:39]
    v_mul_f32 v32, v6, v32
    v_mul_f32 v33, v6, v33
    v_mul_f32 v34, v6, v34
    v_mul_f32 v35, v6, v35
    v_mul_f32 v36, v6, v36
    v_mul_f32 v37, v6, v37
    v_mul_f32 v38, v6, v38
    v_mul_f32 v39, v6, v39
    v_mul_f32 v40, s11, v32
    v_mul_f32 v41, s11, v33
    v_mul_f32 v42, s11, v34
    v_mul_f32 v43, s11, v35
    v_mul_f32 v44, s11, v36
    v_mul_f32 v45, s11, v37
    v_mul_f32 v46, s11, v38
    v_mul_f32 v47, s11, v39
    s_waitcnt lgkmcnt(0)
    v_exp_f32 v40, v40
    v_lshlrev_b32 v96, 16, v96
    v_exp_f32 v41, v41
    v_lshlrev_b32 v97, 16, v97
    v_exp_f32 v42, v42
    v_lshlrev_b32 v98, 16, v98
    v_exp_f32 v43, v43
    v_lshlrev_b32 v99, 16, v99
    v_exp_f32 v44, v44
    v_lshlrev_b32 v100, 16, v100
    v_exp_f32 v45, v45
    v_lshlrev_b32 v101, 16, v101
    v_exp_f32 v46, v46
    v_lshlrev_b32 v102, 16, v102
    v_exp_f32 v47, v47
    v_lshlrev_b32 v103, 16, v103
    v_add_f32 v40, 1.0, v40
    v_mul_f32 v112, v112, v96
    v_add_f32 v41, 1.0, v41
    v_mul_f32 v113, v113, v97
    v_add_f32 v42, 1.0, v42
    v_mul_f32 v114, v114, v98
    v_add_f32 v43, 1.0, v43
    v_mul_f32 v115, v115, v99
    v_add_f32 v44, 1.0, v44
    v_mul_f32 v116, v116, v100
    v_add_f32 v45, 1.0, v45
    v_mul_f32 v117, v117, v101
    v_add_f32 v46, 1.0, v46
    v_mul_f32 v118, v118, v102
    v_add_f32 v47, 1.0, v47
    v_mul_f32 v119, v119, v103
    v_rcp_f32 v40, v40
    v_mul_f32 v112, v112, v32
    v_rcp_f32 v41, v41
    v_mul_f32 v113, v113, v33
    v_rcp_f32 v42, v42
    v_mul_f32 v114, v114, v34
    v_rcp_f32 v43, v43
    v_mul_f32 v115, v115, v35
    v_rcp_f32 v44, v44
    v_mul_f32 v116, v116, v36
    v_rcp_f32 v45, v45
    v_mul_f32 v117, v117, v37
    v_rcp_f32 v46, v46
    v_mul_f32 v118, v118, v38
    v_rcp_f32 v47, v47
    v_mul_f32 v119, v119, v39
    s_nop 0
    v_fma_f32 v104, v112, v40, v104
    v_fma_f32 v105, v113, v41, v105
    v_fma_f32 v106, v114, v42, v106
    v_fma_f32 v107, v115, v43, v107
    v_fma_f32 v108, v116, v44, v108
    v_fma_f32 v109, v117, v45, v109
    v_fma_f32 v110, v118, v46, v110
    v_fma_f32 v111, v119, v47, v111
    v_cvt_pk_bf16_f32 v120, v104, v105
    v_cvt_pk_bf16_f32 v121, v106, v107
    v_cvt_pk_bf16_f32 v122, v108, v109
    v_cvt_pk_bf16_f32 v123, v110, v111
    buffer_store_dwordx4 v[120:123], v3, s[80:83], s43 offen
    s_endpgm
Laux:
    s_sub_u32 s4, s2, 224
    s_lshl_b32 s5, s4, 3
    s_add_u32 s5, s5, s3
    s_cmp_lg_u32 s5, 0
    s_cbranch_scc1 Lnt_51
    s_memrealtime s[8:9]
    s_waitcnt lgkmcnt(0)
    s_or_b32 s8, s8, 1
    v_mov_b32 v2, s8
    buffer_store_dword v2, off, s[84:87], 0 sc1
Lnt_51:
    v_lshrrev_b32 v2, 3, v1
    v_and_b32 v3, 7, v1
    v_lshrrev_b32 v4, 4, v1
    v_and_b32 v5, 15, v1
    s_and_b32 s8, s4, 7
    s_lshr_b32 s9, s4, 3
    s_lshr_b32 s10, s8, 1
    s_lshl_b32 s10, s10, 2
    s_add_u32 s10, s10, s9
    s_and_b32 s8, s8, 1
    s_mul_i32 s8, s8, 14
    s_add_u32 s12, s8, s10
    s_cmp_ge_u32 s10, 14
    s_cselect_b32 s13, 0x80000000, 0
    v_mul_u32_u24 v7, 3584, v2
    v_lshl_add_u32 v7, v3, 4, v7
    v_or_b32 v7, s13, v7
    s_and_b32 s8, s4, 7
    s_lshl_b32 s8, s8, 8
    s_lshr_b32 s9, s4, 3
    s_lshl_b32 s9, s9, 6
    s_add_u32 s8, s8, s9
    s_lshl_b32 s9, s3, 3
    s_add_u32 s6, s8, s9
    v_mul_u32_u24 v8, 896, v2
    v_lshl_add_u32 v8, v3, 4, v8
    s_mul_i32 s7, s6, 896
    s_and_b32 s8, s3, 3
    s_mul_i32 s8, s8, 28672
    s_lshl_b32 s9, s12, 7
    s_add_u32 s8, s8, s9
    s_add_u32 s9, s8, 0
    buffer_load_dwordx4 v[48:51], v7, s[48:51], s9 offen
    s_add_u32 s9, s8, 114688
    buffer_load_dwordx4 v[52:55], v7, s[48:51], s9 offen
    s_waitcnt vmcnt(0)
    buffer_load_dword v15, off, s[84:87], 0 sc1
    s_add_u32 s9, s8, 229376
    buffer_load_dwordx4 v[56:59], v7, s[48:51], s9 offen
    s_add_u32 s9, s8, 344064
    buffer_load_dwordx4 v[60:63], v7, s[48:51], s9 offen
    s_add_u32 s9, s8, 458752
    buffer_load_dwordx4 v[64:67], v7, s[48:51], s9 offen
    s_add_u32 s9, s8, 573440
    buffer_load_dwordx4 v[68:71], v7, s[48:51], s9 offen
    s_add_u32 s9, s8, 688128
    buffer_load_dwordx4 v[72:75], v7, s[48:51], s9 offen
    s_add_u32 s9, s8, 802816
    buffer_load_dwordx4 v[76:79], v7, s[48:51], s9 offen
    s_add_u32 s9, s8, 917504
    buffer_load_dwordx4 v[80:83], v7, s[48:51], s9 offen
    s_add_u32 s9, s8, 1032192
    buffer_load_dwordx4 v[84:87], v7, s[48:51], s9 offen
    s_add_u32 s9, s8, 1146880
    buffer_load_dwordx4 v[88:91], v7, s[48:51], s9 offen
    s_add_u32 s9, s8, 1261568
    buffer_load_dwordx4 v[92:95], v7, s[48:51], s9 offen
    s_add_u32 s9, s8, 1376256
    buffer_load_dwordx4 v[96:99], v7, s[48:51], s9 offen
    s_add_u32 s9, s8, 1490944
    buffer_load_dwordx4 v[100:103], v7, s[48:51], s9 offen
    buffer_load_dwordx4 v[104:107], v8, s[44:47], s7 offen offset:0
    buffer_load_dwordx4 v[108:111], v8, s[44:47], s7 offen offset:128
    buffer_load_dwordx4 v[112:115], v8, s[44:47], s7 offen offset:256
    buffer_load_dwordx4 v[116:119], v8, s[44:47], s7 offen offset:384
    buffer_load_dwordx4 v[120:123], v8, s[44:47], s7 offen offset:512
    buffer_load_dwordx4 v[124:127], v8, s[44:47], s7 offen offset:640
    buffer_load_dwordx4 v[128:131], v8, s[44:47], s7 offen offset:768
    s_waitcnt vmcnt(21)
    v_lshlrev_b32 v16, 16, v48
    v_and_b32 v17, s14, v48
    v_lshlrev_b32 v18, 16, v49
    v_and_b32 v19, s14, v49
    v_lshlrev_b32 v20, 16, v50
    v_and_b32 v21, s14, v50
    v_lshlrev_b32 v22, 16, v51
    v_and_b32 v23, s14, v51
    s_waitcnt vmcnt(20)
    v_lshlrev_b32 v24, 16, v52
    v_and_b32 v25, s14, v52
    v_lshlrev_b32 v26, 16, v53
    v_and_b32 v27, s14, v53
    v_lshlrev_b32 v28, 16, v54
    v_and_b32 v29, s14, v54
    v_lshlrev_b32 v30, 16, v55
    v_and_b32 v31, s14, v55
    v_add_f32 v16, v16, v24
    v_add_f32 v17, v17, v25
    v_add_f32 v18, v18, v26
    v_add_f32 v19, v19, v27
    v_add_f32 v20, v20, v28
    v_add_f32 v21, v21, v29
    v_add_f32 v22, v22, v30
    v_add_f32 v23, v23, v31
    s_waitcnt vmcnt(18)
    v_lshlrev_b32 v24, 16, v56
    v_and_b32 v25, s14, v56
    v_lshlrev_b32 v26, 16, v57
    v_and_b32 v27, s14, v57
    v_lshlrev_b32 v28, 16, v58
    v_and_b32 v29, s14, v58
    v_lshlrev_b32 v30, 16, v59
    v_and_b32 v31, s14, v59
    v_add_f32 v16, v16, v24
    v_add_f32 v17, v17, v25
    v_add_f32 v18, v18, v26
    v_add_f32 v19, v19, v27
    v_add_f32 v20, v20, v28
    v_add_f32 v21, v21, v29
    v_add_f32 v22, v22, v30
    v_add_f32 v23, v23, v31
    s_waitcnt vmcnt(17)
    v_lshlrev_b32 v24, 16, v60
    v_and_b32 v25, s14, v60
    v_lshlrev_b32 v26, 16, v61
    v_and_b32 v27, s14, v61
    v_lshlrev_b32 v28, 16, v62
    v_and_b32 v29, s14, v62
    v_lshlrev_b32 v30, 16, v63
    v_and_b32 v31, s14, v63
    v_add_f32 v16, v16, v24
    v_add_f32 v17, v17, v25
    v_add_f32 v18, v18, v26
    v_add_f32 v19, v19, v27
    v_add_f32 v20, v20, v28
    v_add_f32 v21, v21, v29
    v_add_f32 v22, v22, v30
    v_add_f32 v23, v23, v31
    s_waitcnt vmcnt(16)
    v_lshlrev_b32 v24, 16, v64
    v_and_b32 v25, s14, v64
    v_lshlrev_b32 v26, 16, v65
    v_and_b32 v27, s14, v65
    v_lshlrev_b32 v28, 16, v66
    v_and_b32 v29, s14, v66
    v_lshlrev_b32 v30, 16, v67
    v_and_b32 v31, s14, v67
    v_add_f32 v16, v16, v24
    v_add_f32 v17, v17, v25
    v_add_f32 v18, v18, v26
    v_add_f32 v19, v19, v27
    v_add_f32 v20, v20, v28
    v_add_f32 v21, v21, v29
    v_add_f32 v22, v22, v30
    v_add_f32 v23, v23, v31
    s_waitcnt vmcnt(15)
    v_lshlrev_b32 v24, 16, v68
    v_and_b32 v25, s14, v68
    v_lshlrev_b32 v26, 16, v69
    v_and_b32 v27, s14, v69
    v_lshlrev_b32 v28, 16, v70
    v_and_b32 v29, s14, v70
    v_lshlrev_b32 v30, 16, v71
    v_and_b32 v31, s14, v71
    v_add_f32 v16, v16, v24
    v_add_f32 v17, v17, v25
    v_add_f32 v18, v18, v26
    v_add_f32 v19, v19, v27
    v_add_f32 v20, v20, v28
    v_add_f32 v21, v21, v29
    v_add_f32 v22, v22, v30
    v_add_f32 v23, v23, v31
    s_waitcnt vmcnt(14)
    v_lshlrev_b32 v24, 16, v72
    v_and_b32 v25, s14, v72
    v_lshlrev_b32 v26, 16, v73
    v_and_b32 v27, s14, v73
    v_lshlrev_b32 v28, 16, v74
    v_and_b32 v29, s14, v74
    v_lshlrev_b32 v30, 16, v75
    v_and_b32 v31, s14, v75
    v_add_f32 v16, v16, v24
    v_add_f32 v17, v17, v25
    v_add_f32 v18, v18, v26
    v_add_f32 v19, v19, v27
    v_add_f32 v20, v20, v28
    v_add_f32 v21, v21, v29
    v_add_f32 v22, v22, v30
    v_add_f32 v23, v23, v31
    s_waitcnt vmcnt(13)
    v_lshlrev_b32 v24, 16, v76
    v_and_b32 v25, s14, v76
    v_lshlrev_b32 v26, 16, v77
    v_and_b32 v27, s14, v77
    v_lshlrev_b32 v28, 16, v78
    v_and_b32 v29, s14, v78
    v_lshlrev_b32 v30, 16, v79
    v_and_b32 v31, s14, v79
    v_add_f32 v16, v16, v24
    v_add_f32 v17, v17, v25
    v_add_f32 v18, v18, v26
    v_add_f32 v19, v19, v27
    v_add_f32 v20, v20, v28
    v_add_f32 v21, v21, v29
    v_add_f32 v22, v22, v30
    v_add_f32 v23, v23, v31
    s_waitcnt vmcnt(12)
    v_lshlrev_b32 v24, 16, v80
    v_and_b32 v25, s14, v80
    v_lshlrev_b32 v26, 16, v81
    v_and_b32 v27, s14, v81
    v_lshlrev_b32 v28, 16, v82
    v_and_b32 v29, s14, v82
    v_lshlrev_b32 v30, 16, v83
    v_and_b32 v31, s14, v83
    v_add_f32 v16, v16, v24
    v_add_f32 v17, v17, v25
    v_add_f32 v18, v18, v26
    v_add_f32 v19, v19, v27
    v_add_f32 v20, v20, v28
    v_add_f32 v21, v21, v29
    v_add_f32 v22, v22, v30
    v_add_f32 v23, v23, v31
    s_waitcnt vmcnt(11)
    v_lshlrev_b32 v24, 16, v84
    v_and_b32 v25, s14, v84
    v_lshlrev_b32 v26, 16, v85
    v_and_b32 v27, s14, v85
    v_lshlrev_b32 v28, 16, v86
    v_and_b32 v29, s14, v86
    v_lshlrev_b32 v30, 16, v87
    v_and_b32 v31, s14, v87
    v_add_f32 v16, v16, v24
    v_add_f32 v17, v17, v25
    v_add_f32 v18, v18, v26
    v_add_f32 v19, v19, v27
    v_add_f32 v20, v20, v28
    v_add_f32 v21, v21, v29
    v_add_f32 v22, v22, v30
    v_add_f32 v23, v23, v31
    s_waitcnt vmcnt(10)
    v_lshlrev_b32 v24, 16, v88
    v_and_b32 v25, s14, v88
    v_lshlrev_b32 v26, 16, v89
    v_and_b32 v27, s14, v89
    v_lshlrev_b32 v28, 16, v90
    v_and_b32 v29, s14, v90
    v_lshlrev_b32 v30, 16, v91
    v_and_b32 v31, s14, v91
    v_add_f32 v16, v16, v24
    v_add_f32 v17, v17, v25
    v_add_f32 v18, v18, v26
    v_add_f32 v19, v19, v27
    v_add_f32 v20, v20, v28
    v_add_f32 v21, v21, v29
    v_add_f32 v22, v22, v30
    v_add_f32 v23, v23, v31
    s_waitcnt vmcnt(9)
    v_lshlrev_b32 v24, 16, v92
    v_and_b32 v25, s14, v92
    v_lshlrev_b32 v26, 16, v93
    v_and_b32 v27, s14, v93
    v_lshlrev_b32 v28, 16, v94
    v_and_b32 v29, s14, v94
    v_lshlrev_b32 v30, 16, v95
    v_and_b32 v31, s14, v95
    v_add_f32 v16, v16, v24
    v_add_f32 v17, v17, v25
    v_add_f32 v18, v18, v26
    v_add_f32 v19, v19, v27
    v_add_f32 v20, v20, v28
    v_add_f32 v21, v21, v29
    v_add_f32 v22, v22, v30
    v_add_f32 v23, v23, v31
    s_waitcnt vmcnt(8)
    v_lshlrev_b32 v24, 16, v96
    v_and_b32 v25, s14, v96
    v_lshlrev_b32 v26, 16, v97
    v_and_b32 v27, s14, v97
    v_lshlrev_b32 v28, 16, v98
    v_and_b32 v29, s14, v98
    v_lshlrev_b32 v30, 16, v99
    v_and_b32 v31, s14, v99
    v_add_f32 v16, v16, v24
    v_add_f32 v17, v17, v25
    v_add_f32 v18, v18, v26
    v_add_f32 v19, v19, v27
    v_add_f32 v20, v20, v28
    v_add_f32 v21, v21, v29
    v_add_f32 v22, v22, v30
    v_add_f32 v23, v23, v31
    s_waitcnt vmcnt(7)
    v_lshlrev_b32 v24, 16, v100
    v_and_b32 v25, s14, v100
    v_lshlrev_b32 v26, 16, v101
    v_and_b32 v27, s14, v101
    v_lshlrev_b32 v28, 16, v102
    v_and_b32 v29, s14, v102
    v_lshlrev_b32 v30, 16, v103
    v_and_b32 v31, s14, v103
    v_add_f32 v16, v16, v24
    v_add_f32 v17, v17, v25
    v_add_f32 v18, v18, v26
    v_add_f32 v19, v19, v27
    v_add_f32 v20, v20, v28
    v_add_f32 v21, v21, v29
    v_add_f32 v22, v22, v30
    v_add_f32 v23, v23, v31
    s_nop 1
    v_permlane32_swap_b32 v16, v20
    v_permlane32_swap_b32 v17, v21
    v_permlane32_swap_b32 v18, v22
    v_permlane32_swap_b32 v19, v23
    s_nop 1
    v_add_f32 v16, v16, v20
    v_add_f32 v17, v17, v21
    v_add_f32 v18, v18, v22
    v_add_f32 v19, v19, v23
    s_nop 1
    v_permlane16_swap_b32 v16, v18
    v_permlane16_swap_b32 v17, v19
    s_nop 1
    v_add_f32 v16, v16, v18
    v_add_f32 v17, v17, v19
    s_nop 1
    v_add_f32_dpp v16, v16, v16 row_ror:8 row_mask:0xf bank_mask:0xf
    v_add_f32_dpp v17, v17, v17 row_ror:8 row_mask:0xf bank_mask:0xf
    v_lshrrev_b32 v24, 5, v1
    v_bfe_u32 v25, v1, 4, 1
    v_lshlrev_b32 v26, 5, v3
    v_lshl_add_u32 v26, v24, 4, v26
    v_lshl_add_u32 v26, v25, 3, v26
    s_lshl_b32 s8, s3, 8
    v_add_u32 v26, s8, v26
    ds_write_b64 v26, v[16:17]
    s_waitcnt lgkmcnt(0)
    s_barrier
    s_lshr_b32 s8, s3, 2
    s_lshl_b32 s9, s8, 10
    v_add_u32 v26, s9, v13
    ds_read_b32 v28, v26 offset:0
    ds_read_b32 v29, v26 offset:256
    ds_read_b32 v30, v26 offset:512
    ds_read_b32 v31, v26 offset:768
    s_and_b32 s9, s3, 3
    s_cmp_lg_u32 s9, 0
    s_cselect_b32 s9, 0x80000000, s13
    v_lshlrev_b32 v27, 3, v1
    v_or_b32 v27, s9, v27
    s_mov_b32 s10, s8
    s_waitcnt vmcnt(19)
    s_mov_b32 s9, 0
Ltok_52:
    v_readfirstlane_b32 s42, v15
    s_sub_u32 s8, s0, s42
    s_cmp_lt_i32 s8, 1000
    s_cselect_b32 s8, s42, 0
    s_cmp_gt_u32 s9, 64
    s_cselect_b32 s8, s42, s8
    s_cmp_lg_u32 s8, 0
    s_cbranch_scc1 Ltok_52_ok
    s_add_u32 s9, s9, 1
    s_cmp_gt_u32 s9, 20000
    s_cbranch_scc1 Ltok_52_ok
    s_sleep 8
    buffer_load_dword v15, off, s[84:87], 0 sc1
    s_waitcnt vmcnt(0)
    s_branch Ltok_52
Ltok_52_ok:
    s_waitcnt lgkmcnt(0)
    v_add_f32 v28, v28, v29
    v_add_f32 v30, v30, v31
    v_add_f32 v28, v28, v30
    v_mov_b32 v29, s42
    s_mul_i32 s8, s10, 14336
    s_lshl_b32 s9, s12, 9
    s_add_u32 s8, s8, s9
    s_add_u32 s8, s8, 6356992
    buffer_store_dwordx2 v[28:29], v27, s[52:55], s8 offen sc1
    s_waitcnt vmcnt(1)
    v_mov_b32 v36, 0x3f803f80
    v_mov_b32 v32, 0
    v_mov_b32 v33, 0
    v_mov_b32 v34, 0
    v_mov_b32 v35, 0
    v_dot2_f32_bf16 v32, v104, v36, v32
    v_dot2_f32_bf16 v33, v104, v104, v33
    v_dot2_f32_bf16 v34, v105, v36, v34
    v_dot2_f32_bf16 v35, v105, v105, v35
    v_dot2_f32_bf16 v32, v106, v36, v32
    v_dot2_f32_bf16 v33, v106, v106, v33
    v_dot2_f32_bf16 v34, v107, v36, v34
    v_dot2_f32_bf16 v35, v107, v107, v35
    v_dot2_f32_bf16 v32, v108, v36, v32
    v_dot2_f32_bf16 v33, v108, v108, v33
    v_dot2_f32_bf16 v34, v109, v36, v34
    v_dot2_f32_bf16 v35, v109, v109, v35
    v_dot2_f32_bf16 v32, v110, v36, v32
    v_dot2_f32_bf16 v33, v110, v110, v33
    v_dot2_f32_bf16 v34, v111, v36, v34
    v_dot2_f32_bf16 v35, v111, v111, v35
    v_dot2_f32_bf16 v32, v112, v36, v32
    v_dot2_f32_bf16 v33, v112, v112, v33
    v_dot2_f32_bf16 v34, v113, v36, v34
    v_dot2_f32_bf16 v35, v113, v113, v35
    v_dot2_f32_bf16 v32, v114, v36, v32
    v_dot2_f32_bf16 v33, v114, v114, v33
    v_dot2_f32_bf16 v34, v115, v36, v34
    v_dot2_f32_bf16 v35, v115, v115, v35
    v_dot2_f32_bf16 v32, v116, v36, v32
    v_dot2_f32_bf16 v33, v116, v116, v33
    v_dot2_f32_bf16 v34, v117, v36, v34
    v_dot2_f32_bf16 v35, v117, v117, v35
    v_dot2_f32_bf16 v32, v118, v36, v32
    v_dot2_f32_bf16 v33, v118, v118, v33
    v_dot2_f32_bf16 v34, v119, v36, v34
    v_dot2_f32_bf16 v35, v119, v119, v35
    v_dot2_f32_bf16 v32, v120, v36, v32
    v_dot2_f32_bf16 v33, v120, v120, v33
    v_dot2_f32_bf16 v34, v121, v36, v34
    v_dot2_f32_bf16 v35, v121, v121, v35
    v_dot2_f32_bf16 v32, v122, v36, v32
    v_dot2_f32_bf16 v33, v122, v122, v33
    v_dot2_f32_bf16 v34, v123, v36, v34
    v_dot2_f32_bf16 v35, v123, v123, v35
    v_dot2_f32_bf16 v32, v124, v36, v32
    v_dot2_f32_bf16 v33, v124, v124, v33
    v_dot2_f32_bf16 v34, v125, v36, v34
    v_dot2_f32_bf16 v35, v125, v125, v35
    v_dot2_f32_bf16 v32, v126, v36, v32
    v_dot2_f32_bf16 v33, v126, v126, v33
    v_dot2_f32_bf16 v34, v127, v36, v34
    v_dot2_f32_bf16 v35, v127, v127, v35
    v_dot2_f32_bf16 v32, v128, v36, v32
    v_dot2_f32_bf16 v33, v128, v128, v33
    v_dot2_f32_bf16 v34, v129, v36, v34
    v_dot2_f32_bf16 v35, v129, v129, v35
    v_dot2_f32_bf16 v32, v130, v36, v32
    v_dot2_f32_bf16 v33, v130, v130, v33
    v_dot2_f32_bf16 v34, v131, v36, v34
    v_dot2_f32_bf16 v35, v131, v131, v35
    s_nop 2
    v_add_f32 v32, v32, v34
    v_add_f32 v33, v33, v35
    s_nop 1
    v_add_f32_dpp v32, v32, v32 quad_perm:[1,0,3,2] row_mask:0xf bank_mask:0xf
    v_add_f32_dpp v33, v33, v33 quad_perm:[1,0,3,2] row_mask:0xf bank_mask:0xf
    s_nop 1
    v_add_f32_dpp v32, v32, v32 quad_perm:[2,3,0,1] row_mask:0xf bank_mask:0xf
    v_add_f32_dpp v33, v33, v33 quad_perm:[2,3,0,1] row_mask:0xf bank_mask:0xf
    s_nop 1
    v_add_f32_dpp v32, v32, v32 row_half_mirror row_mask:0xf bank_mask:0xf
    v_add_f32_dpp v33, v33, v33 row_half_mirror row_mask:0xf bank_mask:0xf
    s_nop 1
    v_mul_f32 v32, 0x3b124925, v32
    v_mul_f32 v33, 0x3b124925, v33
    v_fma_f32 v33, -v32, v32, v33
    v_max_f32 v33, 0, v33
    v_add_f32 v33, 0x3727c5ac, v33
    v_rsq_f32 v33, v33
    v_mov_b32 v34, s42
    v_mov_b32 v35, s42
    s_lshl_b32 s8, s6, 4
    s_add_u32 s8, s8, 6291456
    v_lshlrev_b32 v26, 4, v2
    buffer_store_dwordx4 v[32:35], v26, s[52:55], s8 offen sc1
Lend:
    s_endpgm
Lcode_end:
.section .rodata,"a"
.p2align 6
.amdhsa_kernel recurrent_scan__ssm_conv_h3__glu_gated_swiglu__prompt_kernel
  .amdhsa_next_free_vgpr 256
  .amdhsa_next_free_sgpr 102
  .amdhsa_accum_offset 256
  .amdhsa_group_segment_fixed_size 0
  .amdhsa_kernarg_size 104
  .amdhsa_user_sgpr_count 2
  .amdhsa_user_sgpr_kernarg_segment_ptr 1
  .amdhsa_system_sgpr_workgroup_id_x 1
.end_amdhsa_kernel
```
